```python
import torch

def _softmax(x, axis=-1):
    return torch.softmax(x, dim=axis)
def _gelu(x):
    return torch.nn.functional.gelu(x, approximate="tanh")
def _silu(x):
    return torch.nn.functional.silu(x)
def _sigmoid(x):
    return torch.sigmoid(x)
def _layernorm(x, axis=-1, eps=1e-5):
    m = x.mean(dim=axis, keepdim=True)
    v = x.var(dim=axis, keepdim=True, unbiased=False)
    return (x - m) / torch.sqrt(v + eps)
def _scatter_add(tgt, idx, src, axis=0):
    return tgt.clone().index_add_(axis, idx, src)
def _segment_sum(src, seg, n):
    out = torch.zeros((n,) + src.shape[1:], dtype=src.dtype)
    return out.index_add_(0, seg, src)
def _pad(x, pw):
    flat = tuple(v for pair in reversed(pw) for v in pair)
    return torch.nn.functional.pad(x, flat)

kernel_name = 'standalone__kv_cache_quant_int4_int2_kv_with_per_channel_or_per_token_scales__sampling'

def setup_inputs():

    _w = (lambda a: (lambda t: t.to(torch.bfloat16) if t.is_floating_point() else t)(torch.as_tensor(a)))
    B = 16
    Sq = 1
    Skv = 4096
    Hq = 32
    Hkv = 8
    Dh = 128
    bits = 8
    G = 128
    if G <= 0 or G >= Skv:
        G = max(1, Skv // 2)
    Skv = (Skv // G) * G
    ngk = Skv // G
    qmax = (1 << bits) - 1
    return {
        "q": _w((lambda *s: torch.randn(*s, dtype=torch.bfloat16) * 0.4)(B, Hq, Sq, Dh)),
        "qk": _w(torch.randint(0, qmax + 1, (B, Hkv, Skv, Dh)).to(torch.int32)),
        "qv": _w(torch.randint(0, qmax + 1, (B, Hkv, Skv, Dh)).to(torch.int32)),
        "k_scales": _w(torch.abs((lambda *s: torch.randn(*s, dtype=torch.bfloat16) * 0.4)(B, Hkv, ngk, Dh)) * 0.05 + 0.02),
        "k_zeros": _w((lambda *s: torch.randn(*s, dtype=torch.bfloat16) * 0.4)(B, Hkv, ngk, Dh) + float(qmax) / 2.0),
        "v_scales": _w(torch.abs((lambda *s: torch.randn(*s, dtype=torch.bfloat16) * 0.05)(B, Hkv, Skv, 1)) * 0.05 + 0.02),
        "v_zeros": _w((lambda *s: torch.randn(*s, dtype=torch.bfloat16) * 0.05)(B, Hkv, Skv, 1) + float(qmax) / 2.0),
    }

def reference(q, qk, qv, k_scales, k_zeros, v_scales, v_zeros):
    B, Hq, Sq, Dh = q.shape
    Hkv, Skv = qk.shape[1], qk.shape[2]
    ngk = k_scales.shape[2]
    G = Skv // ngk
    ks = (lambda x, n, axis: torch.repeat_interleave(x, n, dim=axis))(k_scales, G, axis=2)
    kz = (lambda x, n, axis: torch.repeat_interleave(x, n, dim=axis))(k_zeros, G, axis=2)
    k = ((lambda x, dt: x.to(dt))(qk, q.dtype) - kz) * ks
    v = ((lambda x, dt: x.to(dt))(qv, q.dtype) - v_zeros) * v_scales
    rep = Hq // Hkv
    if rep > 1:
        k = (lambda x, n, axis: torch.repeat_interleave(x, n, dim=axis))(k, rep, axis=1)
        v = (lambda x, n, axis: torch.repeat_interleave(x, n, dim=axis))(v, rep, axis=1)
    scale = float(Dh) ** -0.5
    logits = torch.einsum("bhqd,bhkd->bhqk", q, k) * scale
    p = _softmax(logits, axis=-1)
    o = torch.einsum("bhqk,bhkd->bhqd", p, v)
    return o
```

```asm
; @launch grid=(256,1,1) block=(320,1,1) lds=98304
.amdgcn_target "amdgcn-amd-amdhsa--gfx950"
.text
.globl standalone__kv_cache_quant_int4_int2_kv_with_per_channel_or_per_token_scales__sampling_kernel
.p2align 8
.type standalone__kv_cache_quant_int4_int2_kv_with_per_channel_or_per_token_scales__sampling_kernel,@function
standalone__kv_cache_quant_int4_int2_kv_with_per_channel_or_per_token_scales__sampling_kernel:
s_cmp_ge_u32 s2, 256
s_cbranch_scc1 L_end
s_load_dwordx16 s[36:51], s[0:1], 0
s_load_dwordx4 s[52:55], s[0:1], 64
v_lshrrev_b32 v1, 6, v0
v_lshlrev_b32 v5, 4, v0
v_readfirstlane_b32 s30, v1
v_and_b32 v0, 63, v0
s_cmp_eq_u32 s30, 4
s_cbranch_scc1 L_help
v_lshrrev_b32 v8, 4, v0
v_and_b32 v9, 3, v0
v_bfe_u32 v10, v0, 2, 2
v_and_b32 v11, 15, v0
v_lshlrev_b32 v1, 13, v1
v_lshl_add_u32 v2, v8, 11, v1
v_lshl_add_u32 v2, v11, 4, v2
v_lshl_add_u32 v1, v10, 11, v1
v_lshl_add_u32 v1, v8, 6, v1
v_lshl_add_u32 v1, v9, 4, v1
v_lshlrev_b32 v3, 5, v8
v_lshl_add_u32 v3, v9, 3, v3
v_lshl_add_u32 v127, v10, 8, v3
s_mov_b32 s11, 0x20000
s_mov_b32 s15, 0x20000
s_mov_b32 s19, 0x20000
s_mov_b32 s23, 0x20000
s_mov_b32 s83, 0x20000
s_mov_b32 s10, 0x10000000
s_mov_b32 s14, 0x100000
s_mov_b32 s18, 0x100000
s_mov_b32 s22, 0x20000
s_mov_b32 s82, 0x100000
s_lshr_b32 s27, s2, 1
s_lshl_b32 s27, s27, 5
s_and_b32 s28, s2, 1
s_or_b32 s27, s27, s28
s_lshl_b32 s33, s27, 8
s_lshl_b32 s27, s27, 16
s_mov_b32 s24, s27
v_lshrrev_b32 v123, 8, v5
v_lshlrev_b32 v123, 9, v123
v_lshl_add_u32 v123, v11, 4, v123
s_add_u32 s25, s24, 0x8000
s_lshl_b32 s26, s2, 12
s_lshr_b32 s35, s2, 1
s_lshl_b32 s35, s35, 10
s_lshl_b32 s56, s30, 5
s_add_u32 s56, s56, 49408
v_lshl_add_u32 v4, v8, 3, s56
s_lshl_b32 s56, s30, 10
s_add_u32 s56, s56, 41216
s_mov_b32 m0, s56
s_waitcnt lgkmcnt(0)
s_mov_b32 s12, s42
s_mov_b32 s13, s43
s_mov_b32 s16, s44
s_mov_b32 s17, s45
s_mov_b32 s20, s36
s_mov_b32 s21, s37
s_mov_b32 s8, s38
s_mov_b32 s9, s39
buffer_load_dwordx4 v123, s[12:15], s33 offen nt lds
s_add_u32 m0, s56, 4096
buffer_load_dwordx2 v[96:97], v127, s[20:23], s35 offen
buffer_load_dwordx4 v123, s[16:19], s33 offen nt lds
buffer_load_dwordx2 v[98:99], v127, s[20:23], s35 offen offset:128
buffer_load_dwordx4 v[8:11], v1, s[8:11], s24 offen offset:0 nt
buffer_load_dwordx4 v[12:15], v1, s[8:11], s24 offen offset:256 nt
buffer_load_dwordx4 v[16:19], v1, s[8:11], s24 offen offset:512 nt
buffer_load_dwordx4 v[20:23], v1, s[8:11], s24 offen offset:768 nt
buffer_load_dwordx4 v[24:27], v1, s[8:11], s24 offen offset:1024 nt
buffer_load_dwordx4 v[28:31], v1, s[8:11], s24 offen offset:1280 nt
s_mov_b32 s12, s46
s_mov_b32 s13, s47
s_mov_b32 s16, s48
s_mov_b32 s17, s49
s_add_u32 m0, s56, 8192
s_mov_b32 s80, s54
s_mov_b32 s81, s55
buffer_load_dwordx4 v123, s[12:15], s33 offen nt lds
s_add_u32 m0, s56, 12288
v_mov_b32 v128, 0
v_mov_b32 v129, 0
v_mov_b32 v130, 0
v_mov_b32 v131, 0
buffer_load_dwordx4 v123, s[16:19], s33 offen nt lds
v_add_u32 v6, 41216, v3
s_lshl_b32 s56, s30, 13
v_lshrrev_b32 v7, 2, v0
v_lshl_add_u32 v7, v7, 5, s56
s_mov_b32 s64, 0x3e0293ee
s_mov_b32 s66, 0x11111111
s_mov_b32 s67, 0x11111111
v_mov_b32 v193, v0
v_mov_b32 v200, v5
v_mov_b32 v5, v1
v_mov_b32 v120, 0xff7fffff
v_mov_b32 v121, 0
v_mov_b32 v0, v7
v_mov_b32 v160, 0
v_mov_b32 v161, 0
v_mov_b32 v162, 0
v_mov_b32 v163, 0
v_mov_b32 v164, 0
v_mov_b32 v165, 0
v_mov_b32 v166, 0
v_mov_b32 v167, 0
v_mov_b32 v168, 0
v_mov_b32 v169, 0
v_mov_b32 v170, 0
v_mov_b32 v171, 0
v_mov_b32 v172, 0
v_mov_b32 v173, 0
v_mov_b32 v174, 0
v_mov_b32 v175, 0
v_mov_b32 v176, 0
v_mov_b32 v177, 0
v_mov_b32 v178, 0
v_mov_b32 v179, 0
v_mov_b32 v180, 0
v_mov_b32 v181, 0
v_mov_b32 v182, 0
v_mov_b32 v183, 0
v_mov_b32 v184, 0
v_mov_b32 v185, 0
v_mov_b32 v186, 0
v_mov_b32 v187, 0
v_mov_b32 v188, 0
v_mov_b32 v189, 0
v_mov_b32 v190, 0
v_mov_b32 v191, 0
s_waitcnt vmcnt(8)
s_barrier
ds_read_b64 v[72:73], v6
ds_read_b64 v[74:75], v6 offset:128
ds_read_b64 v[76:77], v6 offset:4096
ds_read_b64 v[78:79], v6 offset:4224
s_waitcnt lgkmcnt(0)
s_waitcnt vmcnt(5)
s_waitcnt lgkmcnt(2)
v_lshlrev_b32 v80, 16, v72
v_and_b32 v81, 0xffff0000, v72
v_lshlrev_b32 v88, 16, v76
v_and_b32 v89, 0xffff0000, v76
v_lshlrev_b32 v82, 16, v73
v_and_b32 v83, 0xffff0000, v73
v_lshlrev_b32 v90, 16, v77
v_and_b32 v91, 0xffff0000, v77
v_mul_f32 v88, -v88, v80
v_mul_f32 v89, -v89, v81
v_mul_f32 v90, -v90, v82
v_mul_f32 v91, -v91, v83
v_cvt_f32_i32 v8, v8
v_cvt_f32_i32 v9, v9
v_cvt_f32_i32 v10, v10
v_cvt_f32_i32 v11, v11
v_pk_fma_f32 v[8:9], v[8:9], v[80:81], v[88:89]
v_pk_fma_f32 v[10:11], v[10:11], v[82:83], v[90:91]
v_cvt_pk_bf16_f32 v100, v8, v9
v_cvt_pk_bf16_f32 v101, v10, v11
s_waitcnt vmcnt(4)
buffer_load_dwordx4 v[32:35], v5, s[8:11], s24 offen offset:1536 nt
v_lshlrev_b32 v84, 16, v74
v_and_b32 v85, 0xffff0000, v74
v_lshlrev_b32 v92, 16, v78
v_and_b32 v93, 0xffff0000, v78
v_lshlrev_b32 v86, 16, v75
v_and_b32 v87, 0xffff0000, v75
v_lshlrev_b32 v94, 16, v79
v_and_b32 v95, 0xffff0000, v79
v_mul_f32 v92, -v92, v84
v_mul_f32 v93, -v93, v85
v_mul_f32 v94, -v94, v86
v_mul_f32 v95, -v95, v87
v_cvt_f32_i32 v12, v12
v_cvt_f32_i32 v13, v13
v_cvt_f32_i32 v14, v14
v_cvt_f32_i32 v15, v15
v_pk_fma_f32 v[12:13], v[12:13], v[84:85], v[92:93]
v_pk_fma_f32 v[14:15], v[14:15], v[86:87], v[94:95]
v_cvt_pk_bf16_f32 v102, v12, v13
v_cvt_pk_bf16_f32 v103, v14, v15
s_nop 1
v_mfma_f32_16x16x32_bf16 v[104:107], v[100:103], v[96:99], 0
s_waitcnt vmcnt(4)
buffer_load_dwordx4 v[36:39], v5, s[8:11], s24 offen offset:1792 nt
v_cvt_f32_i32 v16, v16
v_cvt_f32_i32 v17, v17
v_cvt_f32_i32 v18, v18
v_cvt_f32_i32 v19, v19
v_pk_fma_f32 v[16:17], v[16:17], v[80:81], v[88:89]
v_pk_fma_f32 v[18:19], v[18:19], v[82:83], v[90:91]
v_cvt_pk_bf16_f32 v100, v16, v17
v_cvt_pk_bf16_f32 v101, v18, v19
s_waitcnt vmcnt(4)
buffer_load_dwordx4 v[40:43], v5, s[8:11], s25 offen offset:0 nt
v_mov_b32_dpp v112, v104 quad_perm:[0,0,0,0] row_mask:0xf bank_mask:0xf
v_cvt_f32_i32 v20, v20
v_cvt_f32_i32 v21, v21
v_add_f32_dpp v112, v105, v112 quad_perm:[1,1,1,1] row_mask:0xf bank_mask:0xf
v_cvt_f32_i32 v22, v22
v_cvt_f32_i32 v23, v23
v_add_f32_dpp v112, v106, v112 quad_perm:[2,2,2,2] row_mask:0xf bank_mask:0xf
v_pk_fma_f32 v[20:21], v[20:21], v[84:85], v[92:93]
v_pk_fma_f32 v[22:23], v[22:23], v[86:87], v[94:95]
v_add_f32_dpp v112, v107, v112 quad_perm:[3,3,3,3] row_mask:0xf bank_mask:0xf
v_cvt_pk_bf16_f32 v102, v20, v21
v_cvt_pk_bf16_f32 v103, v22, v23
s_nop 1
v_mfma_f32_16x16x32_bf16 v[108:111], v[100:103], v[96:99], 0
s_waitcnt vmcnt(4)
buffer_load_dwordx4 v[44:47], v5, s[8:11], s25 offen offset:256 nt
v_cvt_f32_i32 v24, v24
v_cvt_f32_i32 v25, v25
v_cvt_f32_i32 v26, v26
v_cvt_f32_i32 v27, v27
v_pk_fma_f32 v[24:25], v[24:25], v[80:81], v[88:89]
v_pk_fma_f32 v[26:27], v[26:27], v[82:83], v[90:91]
v_cvt_pk_bf16_f32 v100, v24, v25
v_cvt_pk_bf16_f32 v101, v26, v27
s_waitcnt vmcnt(4)
buffer_load_dwordx4 v[48:51], v5, s[8:11], s25 offen offset:512 nt
v_mov_b32_dpp v113, v108 quad_perm:[0,0,0,0] row_mask:0xf bank_mask:0xf
v_cvt_f32_i32 v28, v28
v_cvt_f32_i32 v29, v29
v_add_f32_dpp v113, v109, v113 quad_perm:[1,1,1,1] row_mask:0xf bank_mask:0xf
v_cvt_f32_i32 v30, v30
v_cvt_f32_i32 v31, v31
v_add_f32_dpp v113, v110, v113 quad_perm:[2,2,2,2] row_mask:0xf bank_mask:0xf
v_pk_fma_f32 v[28:29], v[28:29], v[84:85], v[92:93]
v_pk_fma_f32 v[30:31], v[30:31], v[86:87], v[94:95]
v_add_f32_dpp v113, v111, v113 quad_perm:[3,3,3,3] row_mask:0xf bank_mask:0xf
v_cvt_pk_bf16_f32 v102, v28, v29
v_cvt_pk_bf16_f32 v103, v30, v31
s_nop 1
v_mfma_f32_16x16x32_bf16 v[104:107], v[100:103], v[96:99], 0
s_waitcnt vmcnt(4)
buffer_load_dwordx4 v[52:55], v5, s[8:11], s25 offen offset:768 nt
v_cvt_f32_i32 v32, v32
v_cvt_f32_i32 v33, v33
v_cvt_f32_i32 v34, v34
v_cvt_f32_i32 v35, v35
v_pk_fma_f32 v[32:33], v[32:33], v[80:81], v[88:89]
v_pk_fma_f32 v[34:35], v[34:35], v[82:83], v[90:91]
v_cvt_pk_bf16_f32 v100, v32, v33
v_cvt_pk_bf16_f32 v101, v34, v35
s_waitcnt vmcnt(4)
buffer_load_dwordx4 v[56:59], v5, s[8:11], s25 offen offset:1024 nt
v_mov_b32_dpp v114, v104 quad_perm:[0,0,0,0] row_mask:0xf bank_mask:0xf
v_cvt_f32_i32 v36, v36
v_cvt_f32_i32 v37, v37
v_add_f32_dpp v114, v105, v114 quad_perm:[1,1,1,1] row_mask:0xf bank_mask:0xf
v_cvt_f32_i32 v38, v38
v_cvt_f32_i32 v39, v39
v_add_f32_dpp v114, v106, v114 quad_perm:[2,2,2,2] row_mask:0xf bank_mask:0xf
v_pk_fma_f32 v[36:37], v[36:37], v[84:85], v[92:93]
v_pk_fma_f32 v[38:39], v[38:39], v[86:87], v[94:95]
v_add_f32_dpp v114, v107, v114 quad_perm:[3,3,3,3] row_mask:0xf bank_mask:0xf
v_cvt_pk_bf16_f32 v102, v36, v37
v_cvt_pk_bf16_f32 v103, v38, v39
s_nop 1
v_mfma_f32_16x16x32_bf16 v[108:111], v[100:103], v[96:99], 0
s_waitcnt vmcnt(4)
buffer_load_dwordx4 v[60:63], v5, s[8:11], s25 offen offset:1280 nt
v_cvt_f32_i32 v40, v40
v_cvt_f32_i32 v41, v41
v_cvt_f32_i32 v42, v42
v_cvt_f32_i32 v43, v43
v_pk_fma_f32 v[40:41], v[40:41], v[80:81], v[88:89]
v_pk_fma_f32 v[42:43], v[42:43], v[82:83], v[90:91]
v_cvt_pk_bf16_f32 v100, v40, v41
v_cvt_pk_bf16_f32 v101, v42, v43
s_waitcnt vmcnt(4)
buffer_load_dwordx4 v[64:67], v5, s[8:11], s25 offen offset:1536 nt
v_mov_b32_dpp v115, v108 quad_perm:[0,0,0,0] row_mask:0xf bank_mask:0xf
v_cvt_f32_i32 v44, v44
v_cvt_f32_i32 v45, v45
v_add_f32_dpp v115, v109, v115 quad_perm:[1,1,1,1] row_mask:0xf bank_mask:0xf
v_cvt_f32_i32 v46, v46
v_cvt_f32_i32 v47, v47
v_add_f32_dpp v115, v110, v115 quad_perm:[2,2,2,2] row_mask:0xf bank_mask:0xf
v_pk_fma_f32 v[44:45], v[44:45], v[84:85], v[92:93]
v_pk_fma_f32 v[46:47], v[46:47], v[86:87], v[94:95]
v_add_f32_dpp v115, v111, v115 quad_perm:[3,3,3,3] row_mask:0xf bank_mask:0xf
v_cvt_pk_bf16_f32 v102, v44, v45
v_cvt_pk_bf16_f32 v103, v46, v47
s_nop 1
v_mfma_f32_16x16x32_bf16 v[104:107], v[100:103], v[96:99], 0
s_waitcnt vmcnt(4)
buffer_load_dwordx4 v[68:71], v5, s[8:11], s25 offen offset:1792 nt
v_cvt_f32_i32 v48, v48
v_cvt_f32_i32 v49, v49
v_cvt_f32_i32 v50, v50
v_cvt_f32_i32 v51, v51
v_pk_fma_f32 v[48:49], v[48:49], v[80:81], v[88:89]
v_pk_fma_f32 v[50:51], v[50:51], v[82:83], v[90:91]
v_cvt_pk_bf16_f32 v100, v48, v49
v_cvt_pk_bf16_f32 v101, v50, v51
s_waitcnt vmcnt(4)
s_add_u32 s24, s24, 131072
s_add_u32 s25, s25, 131072
v_add_u32 v6, 256, v6
ds_read_b64 v[72:73], v6
ds_read_b64 v[74:75], v6 offset:128
ds_read_b64 v[76:77], v6 offset:4096
ds_read_b64 v[78:79], v6 offset:4224
buffer_load_dwordx4 v[8:11], v5, s[8:11], s24 offen offset:0 nt
v_mov_b32_dpp v116, v104 quad_perm:[0,0,0,0] row_mask:0xf bank_mask:0xf
v_cvt_f32_i32 v52, v52
v_cvt_f32_i32 v53, v53
v_add_f32_dpp v116, v105, v116 quad_perm:[1,1,1,1] row_mask:0xf bank_mask:0xf
v_cvt_f32_i32 v54, v54
v_cvt_f32_i32 v55, v55
v_add_f32_dpp v116, v106, v116 quad_perm:[2,2,2,2] row_mask:0xf bank_mask:0xf
v_pk_fma_f32 v[52:53], v[52:53], v[84:85], v[92:93]
v_pk_fma_f32 v[54:55], v[54:55], v[86:87], v[94:95]
v_add_f32_dpp v116, v107, v116 quad_perm:[3,3,3,3] row_mask:0xf bank_mask:0xf
v_cvt_pk_bf16_f32 v102, v52, v53
v_cvt_pk_bf16_f32 v103, v54, v55
s_nop 1
v_mfma_f32_16x16x32_bf16 v[108:111], v[100:103], v[96:99], 0
s_waitcnt vmcnt(4)
buffer_load_dwordx4 v[12:15], v5, s[8:11], s24 offen offset:256 nt
v_cvt_f32_i32 v56, v56
v_cvt_f32_i32 v57, v57
v_cvt_f32_i32 v58, v58
v_cvt_f32_i32 v59, v59
v_pk_fma_f32 v[56:57], v[56:57], v[80:81], v[88:89]
v_pk_fma_f32 v[58:59], v[58:59], v[82:83], v[90:91]
v_cvt_pk_bf16_f32 v100, v56, v57
v_cvt_pk_bf16_f32 v101, v58, v59
s_waitcnt vmcnt(4)
buffer_load_dwordx4 v[16:19], v5, s[8:11], s24 offen offset:512 nt
v_mov_b32_dpp v117, v108 quad_perm:[0,0,0,0] row_mask:0xf bank_mask:0xf
v_cvt_f32_i32 v60, v60
v_cvt_f32_i32 v61, v61
v_add_f32_dpp v117, v109, v117 quad_perm:[1,1,1,1] row_mask:0xf bank_mask:0xf
v_cvt_f32_i32 v62, v62
v_cvt_f32_i32 v63, v63
v_add_f32_dpp v117, v110, v117 quad_perm:[2,2,2,2] row_mask:0xf bank_mask:0xf
v_pk_fma_f32 v[60:61], v[60:61], v[84:85], v[92:93]
v_pk_fma_f32 v[62:63], v[62:63], v[86:87], v[94:95]
v_add_f32_dpp v117, v111, v117 quad_perm:[3,3,3,3] row_mask:0xf bank_mask:0xf
v_cvt_pk_bf16_f32 v102, v60, v61
v_cvt_pk_bf16_f32 v103, v62, v63
s_nop 1
v_mfma_f32_16x16x32_bf16 v[104:107], v[100:103], v[96:99], 0
s_waitcnt vmcnt(4)
buffer_load_dwordx4 v[20:23], v5, s[8:11], s24 offen offset:768 nt
v_cvt_f32_i32 v64, v64
v_cvt_f32_i32 v65, v65
v_cvt_f32_i32 v66, v66
v_cvt_f32_i32 v67, v67
v_pk_fma_f32 v[64:65], v[64:65], v[80:81], v[88:89]
v_pk_fma_f32 v[66:67], v[66:67], v[82:83], v[90:91]
v_cvt_pk_bf16_f32 v100, v64, v65
v_cvt_pk_bf16_f32 v101, v66, v67
s_waitcnt vmcnt(4)
buffer_load_dwordx4 v[24:27], v5, s[8:11], s24 offen offset:1024 nt
v_mov_b32_dpp v118, v104 quad_perm:[0,0,0,0] row_mask:0xf bank_mask:0xf
v_cvt_f32_i32 v68, v68
v_cvt_f32_i32 v69, v69
v_add_f32_dpp v118, v105, v118 quad_perm:[1,1,1,1] row_mask:0xf bank_mask:0xf
v_cvt_f32_i32 v70, v70
v_cvt_f32_i32 v71, v71
v_add_f32_dpp v118, v106, v118 quad_perm:[2,2,2,2] row_mask:0xf bank_mask:0xf
v_pk_fma_f32 v[68:69], v[68:69], v[84:85], v[92:93]
v_pk_fma_f32 v[70:71], v[70:71], v[86:87], v[94:95]
v_add_f32_dpp v118, v107, v118 quad_perm:[3,3,3,3] row_mask:0xf bank_mask:0xf
v_cvt_pk_bf16_f32 v102, v68, v69
v_cvt_pk_bf16_f32 v103, v70, v71
s_nop 1
v_mfma_f32_16x16x32_bf16 v[108:111], v[100:103], v[96:99], 0
v_max3_f32 v120, v112, v113, v120
v_max3_f32 v120, v114, v115, v120
v_max3_f32 v120, v116, v117, v120
s_mov_b64 exec, s[66:67]
ds_write_b128 v0, v[112:115]
s_mov_b64 exec, -1
s_nop 1
v_mov_b32_dpp v119, v108 quad_perm:[0,0,0,0] row_mask:0xf bank_mask:0xf
s_nop 1
v_add_f32_dpp v119, v109, v119 quad_perm:[1,1,1,1] row_mask:0xf bank_mask:0xf
s_nop 1
v_add_f32_dpp v119, v110, v119 quad_perm:[2,2,2,2] row_mask:0xf bank_mask:0xf
s_nop 1
v_add_f32_dpp v119, v111, v119 quad_perm:[3,3,3,3] row_mask:0xf bank_mask:0xf
s_nop 1
v_max3_f32 v120, v118, v119, v120
s_mov_b64 exec, s[66:67]
ds_write_b128 v0, v[116:119] offset:16
s_mov_b64 exec, -1
v_add_u32 v0, 512, v0
s_mov_b32 s29, 1
L_k:
s_waitcnt vmcnt(4)
buffer_load_dwordx4 v[28:31], v5, s[8:11], s24 offen offset:1280 nt
s_waitcnt lgkmcnt(2)
v_lshlrev_b32 v80, 16, v72
v_and_b32 v81, 0xffff0000, v72
v_lshlrev_b32 v88, 16, v76
v_and_b32 v89, 0xffff0000, v76
v_lshlrev_b32 v82, 16, v73
v_and_b32 v83, 0xffff0000, v73
v_lshlrev_b32 v90, 16, v77
v_and_b32 v91, 0xffff0000, v77
v_mul_f32 v88, -v88, v80
v_mul_f32 v89, -v89, v81
v_mul_f32 v90, -v90, v82
v_mul_f32 v91, -v91, v83
v_cvt_f32_i32 v8, v8
v_cvt_f32_i32 v9, v9
v_cvt_f32_i32 v10, v10
v_cvt_f32_i32 v11, v11
v_pk_fma_f32 v[8:9], v[8:9], v[80:81], v[88:89]
v_pk_fma_f32 v[10:11], v[10:11], v[82:83], v[90:91]
v_cvt_pk_bf16_f32 v100, v8, v9
v_cvt_pk_bf16_f32 v101, v10, v11
s_waitcnt vmcnt(4)
buffer_load_dwordx4 v[32:35], v5, s[8:11], s24 offen offset:1536 nt
v_lshlrev_b32 v84, 16, v74
v_and_b32 v85, 0xffff0000, v74
v_lshlrev_b32 v92, 16, v78
v_and_b32 v93, 0xffff0000, v78
v_lshlrev_b32 v86, 16, v75
v_and_b32 v87, 0xffff0000, v75
v_lshlrev_b32 v94, 16, v79
v_and_b32 v95, 0xffff0000, v79
v_mul_f32 v92, -v92, v84
v_mul_f32 v93, -v93, v85
v_mul_f32 v94, -v94, v86
v_mul_f32 v95, -v95, v87
v_cvt_f32_i32 v12, v12
v_cvt_f32_i32 v13, v13
v_cvt_f32_i32 v14, v14
v_cvt_f32_i32 v15, v15
v_pk_fma_f32 v[12:13], v[12:13], v[84:85], v[92:93]
v_pk_fma_f32 v[14:15], v[14:15], v[86:87], v[94:95]
v_cvt_pk_bf16_f32 v102, v12, v13
v_cvt_pk_bf16_f32 v103, v14, v15
s_nop 1
v_mfma_f32_16x16x32_bf16 v[104:107], v[100:103], v[96:99], 0
s_waitcnt vmcnt(4)
buffer_load_dwordx4 v[36:39], v5, s[8:11], s24 offen offset:1792 nt
v_cvt_f32_i32 v16, v16
v_cvt_f32_i32 v17, v17
v_cvt_f32_i32 v18, v18
v_cvt_f32_i32 v19, v19
v_pk_fma_f32 v[16:17], v[16:17], v[80:81], v[88:89]
v_pk_fma_f32 v[18:19], v[18:19], v[82:83], v[90:91]
v_cvt_pk_bf16_f32 v100, v16, v17
v_cvt_pk_bf16_f32 v101, v18, v19
s_waitcnt vmcnt(4)
buffer_load_dwordx4 v[40:43], v5, s[8:11], s25 offen offset:0 nt
v_mov_b32_dpp v112, v104 quad_perm:[0,0,0,0] row_mask:0xf bank_mask:0xf
v_cvt_f32_i32 v20, v20
v_cvt_f32_i32 v21, v21
v_add_f32_dpp v112, v105, v112 quad_perm:[1,1,1,1] row_mask:0xf bank_mask:0xf
v_cvt_f32_i32 v22, v22
v_cvt_f32_i32 v23, v23
v_add_f32_dpp v112, v106, v112 quad_perm:[2,2,2,2] row_mask:0xf bank_mask:0xf
v_pk_fma_f32 v[20:21], v[20:21], v[84:85], v[92:93]
v_pk_fma_f32 v[22:23], v[22:23], v[86:87], v[94:95]
v_add_f32_dpp v112, v107, v112 quad_perm:[3,3,3,3] row_mask:0xf bank_mask:0xf
v_cvt_pk_bf16_f32 v102, v20, v21
v_cvt_pk_bf16_f32 v103, v22, v23
s_nop 1
v_mfma_f32_16x16x32_bf16 v[108:111], v[100:103], v[96:99], 0
s_waitcnt vmcnt(4)
buffer_load_dwordx4 v[44:47], v5, s[8:11], s25 offen offset:256 nt
v_cvt_f32_i32 v24, v24
v_cvt_f32_i32 v25, v25
v_cvt_f32_i32 v26, v26
v_cvt_f32_i32 v27, v27
v_pk_fma_f32 v[24:25], v[24:25], v[80:81], v[88:89]
v_pk_fma_f32 v[26:27], v[26:27], v[82:83], v[90:91]
v_cvt_pk_bf16_f32 v100, v24, v25
v_cvt_pk_bf16_f32 v101, v26, v27
s_waitcnt vmcnt(4)
buffer_load_dwordx4 v[48:51], v5, s[8:11], s25 offen offset:512 nt
v_mov_b32_dpp v113, v108 quad_perm:[0,0,0,0] row_mask:0xf bank_mask:0xf
v_cvt_f32_i32 v28, v28
v_cvt_f32_i32 v29, v29
v_add_f32_dpp v113, v109, v113 quad_perm:[1,1,1,1] row_mask:0xf bank_mask:0xf
v_cvt_f32_i32 v30, v30
v_cvt_f32_i32 v31, v31
v_add_f32_dpp v113, v110, v113 quad_perm:[2,2,2,2] row_mask:0xf bank_mask:0xf
v_pk_fma_f32 v[28:29], v[28:29], v[84:85], v[92:93]
v_pk_fma_f32 v[30:31], v[30:31], v[86:87], v[94:95]
v_add_f32_dpp v113, v111, v113 quad_perm:[3,3,3,3] row_mask:0xf bank_mask:0xf
v_cvt_pk_bf16_f32 v102, v28, v29
v_cvt_pk_bf16_f32 v103, v30, v31
s_nop 1
v_mfma_f32_16x16x32_bf16 v[104:107], v[100:103], v[96:99], 0
s_waitcnt vmcnt(4)
buffer_load_dwordx4 v[52:55], v5, s[8:11], s25 offen offset:768 nt
v_cvt_f32_i32 v32, v32
v_cvt_f32_i32 v33, v33
v_cvt_f32_i32 v34, v34
v_cvt_f32_i32 v35, v35
v_pk_fma_f32 v[32:33], v[32:33], v[80:81], v[88:89]
v_pk_fma_f32 v[34:35], v[34:35], v[82:83], v[90:91]
v_cvt_pk_bf16_f32 v100, v32, v33
v_cvt_pk_bf16_f32 v101, v34, v35
s_waitcnt vmcnt(4)
buffer_load_dwordx4 v[56:59], v5, s[8:11], s25 offen offset:1024 nt
v_mov_b32_dpp v114, v104 quad_perm:[0,0,0,0] row_mask:0xf bank_mask:0xf
v_cvt_f32_i32 v36, v36
v_cvt_f32_i32 v37, v37
v_add_f32_dpp v114, v105, v114 quad_perm:[1,1,1,1] row_mask:0xf bank_mask:0xf
v_cvt_f32_i32 v38, v38
v_cvt_f32_i32 v39, v39
v_add_f32_dpp v114, v106, v114 quad_perm:[2,2,2,2] row_mask:0xf bank_mask:0xf
v_pk_fma_f32 v[36:37], v[36:37], v[84:85], v[92:93]
v_pk_fma_f32 v[38:39], v[38:39], v[86:87], v[94:95]
v_add_f32_dpp v114, v107, v114 quad_perm:[3,3,3,3] row_mask:0xf bank_mask:0xf
v_cvt_pk_bf16_f32 v102, v36, v37
v_cvt_pk_bf16_f32 v103, v38, v39
s_nop 1
v_mfma_f32_16x16x32_bf16 v[108:111], v[100:103], v[96:99], 0
s_waitcnt vmcnt(4)
buffer_load_dwordx4 v[60:63], v5, s[8:11], s25 offen offset:1280 nt
v_cvt_f32_i32 v40, v40
v_cvt_f32_i32 v41, v41
v_cvt_f32_i32 v42, v42
v_cvt_f32_i32 v43, v43
v_pk_fma_f32 v[40:41], v[40:41], v[80:81], v[88:89]
v_pk_fma_f32 v[42:43], v[42:43], v[82:83], v[90:91]
v_cvt_pk_bf16_f32 v100, v40, v41
v_cvt_pk_bf16_f32 v101, v42, v43
s_waitcnt vmcnt(4)
buffer_load_dwordx4 v[64:67], v5, s[8:11], s25 offen offset:1536 nt
v_mov_b32_dpp v115, v108 quad_perm:[0,0,0,0] row_mask:0xf bank_mask:0xf
v_cvt_f32_i32 v44, v44
v_cvt_f32_i32 v45, v45
v_add_f32_dpp v115, v109, v115 quad_perm:[1,1,1,1] row_mask:0xf bank_mask:0xf
v_cvt_f32_i32 v46, v46
v_cvt_f32_i32 v47, v47
v_add_f32_dpp v115, v110, v115 quad_perm:[2,2,2,2] row_mask:0xf bank_mask:0xf
v_pk_fma_f32 v[44:45], v[44:45], v[84:85], v[92:93]
v_pk_fma_f32 v[46:47], v[46:47], v[86:87], v[94:95]
v_add_f32_dpp v115, v111, v115 quad_perm:[3,3,3,3] row_mask:0xf bank_mask:0xf
v_cvt_pk_bf16_f32 v102, v44, v45
v_cvt_pk_bf16_f32 v103, v46, v47
s_nop 1
v_mfma_f32_16x16x32_bf16 v[104:107], v[100:103], v[96:99], 0
s_waitcnt vmcnt(4)
buffer_load_dwordx4 v[68:71], v5, s[8:11], s25 offen offset:1792 nt
v_cvt_f32_i32 v48, v48
v_cvt_f32_i32 v49, v49
v_cvt_f32_i32 v50, v50
v_cvt_f32_i32 v51, v51
v_pk_fma_f32 v[48:49], v[48:49], v[80:81], v[88:89]
v_pk_fma_f32 v[50:51], v[50:51], v[82:83], v[90:91]
v_cvt_pk_bf16_f32 v100, v48, v49
v_cvt_pk_bf16_f32 v101, v50, v51
s_waitcnt vmcnt(4)
s_add_u32 s24, s24, 131072
s_add_u32 s25, s25, 131072
v_add_u32 v6, 256, v6
s_add_u32 s29, s29, 1
s_cmp_lt_u32 s29, 16
s_cbranch_scc1 L_k_go1
s_mov_b32 s8, s40
s_mov_b32 s9, s41
v_mov_b32 v5, v2
v_mov_b32 v6, v4
s_mov_b32 s24, s27
s_add_u32 s25, s24, 0x8000
s_barrier
L_k_go1:
ds_read_b64 v[72:73], v6
ds_read_b64 v[74:75], v6 offset:128
ds_read_b64 v[76:77], v6 offset:4096
ds_read_b64 v[78:79], v6 offset:4224
buffer_load_dwordx4 v[8:11], v5, s[8:11], s24 offen offset:0 nt
v_mov_b32_dpp v116, v104 quad_perm:[0,0,0,0] row_mask:0xf bank_mask:0xf
v_cvt_f32_i32 v52, v52
v_cvt_f32_i32 v53, v53
v_add_f32_dpp v116, v105, v116 quad_perm:[1,1,1,1] row_mask:0xf bank_mask:0xf
v_cvt_f32_i32 v54, v54
v_cvt_f32_i32 v55, v55
v_add_f32_dpp v116, v106, v116 quad_perm:[2,2,2,2] row_mask:0xf bank_mask:0xf
v_pk_fma_f32 v[52:53], v[52:53], v[84:85], v[92:93]
v_pk_fma_f32 v[54:55], v[54:55], v[86:87], v[94:95]
v_add_f32_dpp v116, v107, v116 quad_perm:[3,3,3,3] row_mask:0xf bank_mask:0xf
v_cvt_pk_bf16_f32 v102, v52, v53
v_cvt_pk_bf16_f32 v103, v54, v55
s_nop 1
v_mfma_f32_16x16x32_bf16 v[108:111], v[100:103], v[96:99], 0
s_waitcnt vmcnt(4)
buffer_load_dwordx4 v[12:15], v5, s[8:11], s24 offen offset:256 nt
v_cvt_f32_i32 v56, v56
v_cvt_f32_i32 v57, v57
v_cvt_f32_i32 v58, v58
v_cvt_f32_i32 v59, v59
v_pk_fma_f32 v[56:57], v[56:57], v[80:81], v[88:89]
v_pk_fma_f32 v[58:59], v[58:59], v[82:83], v[90:91]
v_cvt_pk_bf16_f32 v100, v56, v57
v_cvt_pk_bf16_f32 v101, v58, v59
s_waitcnt vmcnt(4)
buffer_load_dwordx4 v[16:19], v5, s[8:11], s24 offen offset:512 nt
v_mov_b32_dpp v117, v108 quad_perm:[0,0,0,0] row_mask:0xf bank_mask:0xf
v_cvt_f32_i32 v60, v60
v_cvt_f32_i32 v61, v61
v_add_f32_dpp v117, v109, v117 quad_perm:[1,1,1,1] row_mask:0xf bank_mask:0xf
v_cvt_f32_i32 v62, v62
v_cvt_f32_i32 v63, v63
v_add_f32_dpp v117, v110, v117 quad_perm:[2,2,2,2] row_mask:0xf bank_mask:0xf
v_pk_fma_f32 v[60:61], v[60:61], v[84:85], v[92:93]
v_pk_fma_f32 v[62:63], v[62:63], v[86:87], v[94:95]
v_add_f32_dpp v117, v111, v117 quad_perm:[3,3,3,3] row_mask:0xf bank_mask:0xf
v_cvt_pk_bf16_f32 v102, v60, v61
v_cvt_pk_bf16_f32 v103, v62, v63
s_nop 1
v_mfma_f32_16x16x32_bf16 v[104:107], v[100:103], v[96:99], 0
s_waitcnt vmcnt(4)
buffer_load_dwordx4 v[20:23], v5, s[8:11], s24 offen offset:768 nt
v_cvt_f32_i32 v64, v64
v_cvt_f32_i32 v65, v65
v_cvt_f32_i32 v66, v66
v_cvt_f32_i32 v67, v67
v_pk_fma_f32 v[64:65], v[64:65], v[80:81], v[88:89]
v_pk_fma_f32 v[66:67], v[66:67], v[82:83], v[90:91]
v_cvt_pk_bf16_f32 v100, v64, v65
v_cvt_pk_bf16_f32 v101, v66, v67
s_waitcnt vmcnt(4)
buffer_load_dwordx4 v[24:27], v5, s[8:11], s24 offen offset:1024 nt
v_mov_b32_dpp v118, v104 quad_perm:[0,0,0,0] row_mask:0xf bank_mask:0xf
v_cvt_f32_i32 v68, v68
v_cvt_f32_i32 v69, v69
v_add_f32_dpp v118, v105, v118 quad_perm:[1,1,1,1] row_mask:0xf bank_mask:0xf
v_cvt_f32_i32 v70, v70
v_cvt_f32_i32 v71, v71
v_add_f32_dpp v118, v106, v118 quad_perm:[2,2,2,2] row_mask:0xf bank_mask:0xf
v_pk_fma_f32 v[68:69], v[68:69], v[84:85], v[92:93]
v_pk_fma_f32 v[70:71], v[70:71], v[86:87], v[94:95]
v_add_f32_dpp v118, v107, v118 quad_perm:[3,3,3,3] row_mask:0xf bank_mask:0xf
v_cvt_pk_bf16_f32 v102, v68, v69
v_cvt_pk_bf16_f32 v103, v70, v71
s_nop 1
v_mfma_f32_16x16x32_bf16 v[108:111], v[100:103], v[96:99], 0
v_max3_f32 v120, v112, v113, v120
v_max3_f32 v120, v114, v115, v120
v_max3_f32 v120, v116, v117, v120
s_mov_b64 exec, s[66:67]
ds_write_b128 v0, v[112:115]
s_mov_b64 exec, -1
s_nop 1
v_mov_b32_dpp v119, v108 quad_perm:[0,0,0,0] row_mask:0xf bank_mask:0xf
s_nop 1
v_add_f32_dpp v119, v109, v119 quad_perm:[1,1,1,1] row_mask:0xf bank_mask:0xf
s_nop 1
v_add_f32_dpp v119, v110, v119 quad_perm:[2,2,2,2] row_mask:0xf bank_mask:0xf
s_nop 1
v_add_f32_dpp v119, v111, v119 quad_perm:[3,3,3,3] row_mask:0xf bank_mask:0xf
s_nop 1
v_max3_f32 v120, v118, v119, v120
s_mov_b64 exec, s[66:67]
ds_write_b128 v0, v[116:119] offset:16
s_mov_b64 exec, -1
v_add_u32 v0, 512, v0
s_cmp_lt_u32 s29, 16
s_cbranch_scc1 L_k
v_mov_b32 v123, v120
s_nop 1
v_permlane32_swap_b32 v120, v123
v_max_f32 v120, v120, v123
v_mov_b32 v123, v120
s_nop 1
v_permlane16_swap_b32 v120, v123
v_max_f32 v120, v120, v123
s_lshl_b32 s56, s30, 2
s_add_u32 s56, s56, 40960
v_bfe_u32 v124, v193, 2, 2
v_lshl_add_u32 v124, v124, 4, s56
s_mov_b64 exec, 0x1111
ds_write_b32 v124, v120
s_mov_b64 exec, -1
v_mul_f32 v122, -v120, s64
v_mov_b32 v0, v7
s_mov_b32 s29, 0
s_waitcnt lgkmcnt(0)
s_mov_b32 s31, 15
s_getreg_b32 s57, hwreg(HW_REG_XCC_ID, 0, 1)
s_cmp_eq_u32 s57, 0
s_cselect_b32 s31, 8, 15
L_v:
ds_read_b128 v[112:115], v0
ds_read_b128 v[116:119], v0 offset:16
v_add_u32 v0, 512, v0
s_waitcnt vmcnt(4)
buffer_load_dwordx4 v[28:31], v5, s[8:11], s24 offen offset:1280 nt
s_waitcnt lgkmcnt(2)
v_lshlrev_b32 v80, 16, v72
v_and_b32 v81, 0xffff0000, v72
v_lshlrev_b32 v88, 16, v76
v_and_b32 v89, 0xffff0000, v76
v_cvt_f32_i32 v8, v8
v_cvt_f32_i32 v9, v9
v_cvt_f32_i32 v10, v10
v_cvt_f32_i32 v11, v11
v_pk_add_f32 v[8:9], v[8:9], v[88:89] op_sel:[0,0] op_sel_hi:[1,0] neg_lo:[0,1] neg_hi:[0,1]
v_pk_add_f32 v[10:11], v[10:11], v[88:89] op_sel:[0,0] op_sel_hi:[1,0] neg_lo:[0,1] neg_hi:[0,1]
s_waitcnt vmcnt(4)
buffer_load_dwordx4 v[32:35], v5, s[8:11], s24 offen offset:1536 nt
v_lshlrev_b32 v82, 16, v73
v_and_b32 v83, 0xffff0000, v73
v_lshlrev_b32 v90, 16, v77
v_and_b32 v91, 0xffff0000, v77
v_cvt_f32_i32 v12, v12
v_cvt_f32_i32 v13, v13
v_cvt_f32_i32 v14, v14
v_cvt_f32_i32 v15, v15
v_pk_add_f32 v[12:13], v[12:13], v[88:89] op_sel:[0,0] op_sel_hi:[1,0] neg_lo:[0,1] neg_hi:[0,1]
v_pk_add_f32 v[14:15], v[14:15], v[88:89] op_sel:[0,0] op_sel_hi:[1,0] neg_lo:[0,1] neg_hi:[0,1]
s_waitcnt vmcnt(4)
buffer_load_dwordx4 v[36:39], v5, s[8:11], s24 offen offset:1792 nt
v_lshlrev_b32 v84, 16, v74
v_and_b32 v85, 0xffff0000, v74
v_lshlrev_b32 v92, 16, v78
v_and_b32 v93, 0xffff0000, v78
v_cvt_f32_i32 v16, v16
v_cvt_f32_i32 v17, v17
v_cvt_f32_i32 v18, v18
v_cvt_f32_i32 v19, v19
v_pk_add_f32 v[16:17], v[16:17], v[88:89] op_sel:[0,1] op_sel_hi:[1,1] neg_lo:[0,1] neg_hi:[0,1]
v_pk_add_f32 v[18:19], v[18:19], v[88:89] op_sel:[0,1] op_sel_hi:[1,1] neg_lo:[0,1] neg_hi:[0,1]
v_cvt_pk_bf16_f32 v128, v8, v16
v_cvt_pk_bf16_f32 v132, v9, v17
v_cvt_pk_bf16_f32 v136, v10, v18
v_cvt_pk_bf16_f32 v140, v11, v19
s_waitcnt vmcnt(4)
buffer_load_dwordx4 v[40:43], v5, s[8:11], s25 offen offset:0 nt
v_lshlrev_b32 v86, 16, v75
v_and_b32 v87, 0xffff0000, v75
v_lshlrev_b32 v94, 16, v79
v_and_b32 v95, 0xffff0000, v79
v_cvt_f32_i32 v20, v20
v_cvt_f32_i32 v21, v21
v_cvt_f32_i32 v22, v22
v_cvt_f32_i32 v23, v23
v_pk_add_f32 v[20:21], v[20:21], v[88:89] op_sel:[0,1] op_sel_hi:[1,1] neg_lo:[0,1] neg_hi:[0,1]
v_pk_add_f32 v[22:23], v[22:23], v[88:89] op_sel:[0,1] op_sel_hi:[1,1] neg_lo:[0,1] neg_hi:[0,1]
v_cvt_pk_bf16_f32 v144, v12, v20
v_cvt_pk_bf16_f32 v148, v13, v21
v_cvt_pk_bf16_f32 v152, v14, v22
v_cvt_pk_bf16_f32 v156, v15, v23
s_waitcnt vmcnt(4)
buffer_load_dwordx4 v[44:47], v5, s[8:11], s25 offen offset:256 nt
s_waitcnt lgkmcnt(0)
v_fma_f32 v112, v112, s64, v122
v_exp_f32 v112, v112
v_cvt_f32_i32 v24, v24
v_cvt_f32_i32 v25, v25
v_cvt_f32_i32 v26, v26
v_cvt_f32_i32 v27, v27
v_add_f32 v121, v121, v112
v_mul_f32 v112, v112, v80
v_pk_add_f32 v[24:25], v[24:25], v[90:91] op_sel:[0,0] op_sel_hi:[1,0] neg_lo:[0,1] neg_hi:[0,1]
v_pk_add_f32 v[26:27], v[26:27], v[90:91] op_sel:[0,0] op_sel_hi:[1,0] neg_lo:[0,1] neg_hi:[0,1]
s_waitcnt vmcnt(4)
buffer_load_dwordx4 v[48:51], v5, s[8:11], s25 offen offset:512 nt
v_fma_f32 v113, v113, s64, v122
v_exp_f32 v113, v113
v_cvt_f32_i32 v28, v28
v_cvt_f32_i32 v29, v29
v_cvt_f32_i32 v30, v30
v_cvt_f32_i32 v31, v31
v_add_f32 v121, v121, v113
v_mul_f32 v113, v113, v81
v_pk_add_f32 v[28:29], v[28:29], v[90:91] op_sel:[0,0] op_sel_hi:[1,0] neg_lo:[0,1] neg_hi:[0,1]
v_pk_add_f32 v[30:31], v[30:31], v[90:91] op_sel:[0,0] op_sel_hi:[1,0] neg_lo:[0,1] neg_hi:[0,1]
s_waitcnt vmcnt(4)
buffer_load_dwordx4 v[52:55], v5, s[8:11], s25 offen offset:768 nt
v_fma_f32 v114, v114, s64, v122
v_exp_f32 v114, v114
v_cvt_f32_i32 v32, v32
v_cvt_f32_i32 v33, v33
v_cvt_f32_i32 v34, v34
v_cvt_f32_i32 v35, v35
v_add_f32 v121, v121, v114
v_mul_f32 v114, v114, v82
v_pk_add_f32 v[32:33], v[32:33], v[90:91] op_sel:[0,1] op_sel_hi:[1,1] neg_lo:[0,1] neg_hi:[0,1]
v_pk_add_f32 v[34:35], v[34:35], v[90:91] op_sel:[0,1] op_sel_hi:[1,1] neg_lo:[0,1] neg_hi:[0,1]
v_cvt_pk_bf16_f32 v129, v24, v32
v_cvt_pk_bf16_f32 v133, v25, v33
v_cvt_pk_bf16_f32 v137, v26, v34
v_cvt_pk_bf16_f32 v141, v27, v35
s_waitcnt vmcnt(4)
buffer_load_dwordx4 v[56:59], v5, s[8:11], s25 offen offset:1024 nt
v_fma_f32 v115, v115, s64, v122
v_exp_f32 v115, v115
v_cvt_f32_i32 v36, v36
v_cvt_f32_i32 v37, v37
v_cvt_f32_i32 v38, v38
v_cvt_f32_i32 v39, v39
v_add_f32 v121, v121, v115
v_mul_f32 v115, v115, v83
v_pk_add_f32 v[36:37], v[36:37], v[90:91] op_sel:[0,1] op_sel_hi:[1,1] neg_lo:[0,1] neg_hi:[0,1]
v_pk_add_f32 v[38:39], v[38:39], v[90:91] op_sel:[0,1] op_sel_hi:[1,1] neg_lo:[0,1] neg_hi:[0,1]
v_cvt_pk_bf16_f32 v145, v28, v36
v_cvt_pk_bf16_f32 v149, v29, v37
v_cvt_pk_bf16_f32 v153, v30, v38
v_cvt_pk_bf16_f32 v157, v31, v39
s_waitcnt vmcnt(4)
buffer_load_dwordx4 v[60:63], v5, s[8:11], s25 offen offset:1280 nt
v_fma_f32 v116, v116, s64, v122
v_exp_f32 v116, v116
v_cvt_f32_i32 v40, v40
v_cvt_f32_i32 v41, v41
v_cvt_f32_i32 v42, v42
v_cvt_f32_i32 v43, v43
v_add_f32 v121, v121, v116
v_mul_f32 v116, v116, v84
v_pk_add_f32 v[40:41], v[40:41], v[92:93] op_sel:[0,0] op_sel_hi:[1,0] neg_lo:[0,1] neg_hi:[0,1]
v_pk_add_f32 v[42:43], v[42:43], v[92:93] op_sel:[0,0] op_sel_hi:[1,0] neg_lo:[0,1] neg_hi:[0,1]
s_waitcnt vmcnt(4)
buffer_load_dwordx4 v[64:67], v5, s[8:11], s25 offen offset:1536 nt
v_fma_f32 v117, v117, s64, v122
v_exp_f32 v117, v117
v_cvt_f32_i32 v44, v44
v_cvt_f32_i32 v45, v45
v_cvt_f32_i32 v46, v46
v_cvt_f32_i32 v47, v47
v_add_f32 v121, v121, v117
v_mul_f32 v117, v117, v85
v_pk_add_f32 v[44:45], v[44:45], v[92:93] op_sel:[0,0] op_sel_hi:[1,0] neg_lo:[0,1] neg_hi:[0,1]
v_pk_add_f32 v[46:47], v[46:47], v[92:93] op_sel:[0,0] op_sel_hi:[1,0] neg_lo:[0,1] neg_hi:[0,1]
s_waitcnt vmcnt(4)
buffer_load_dwordx4 v[68:71], v5, s[8:11], s25 offen offset:1792 nt
v_fma_f32 v118, v118, s64, v122
v_exp_f32 v118, v118
v_cvt_f32_i32 v48, v48
v_cvt_f32_i32 v49, v49
v_cvt_f32_i32 v50, v50
v_cvt_f32_i32 v51, v51
v_add_f32 v121, v121, v118
v_mul_f32 v118, v118, v86
v_pk_add_f32 v[48:49], v[48:49], v[92:93] op_sel:[0,1] op_sel_hi:[1,1] neg_lo:[0,1] neg_hi:[0,1]
v_pk_add_f32 v[50:51], v[50:51], v[92:93] op_sel:[0,1] op_sel_hi:[1,1] neg_lo:[0,1] neg_hi:[0,1]
v_cvt_pk_bf16_f32 v130, v40, v48
v_cvt_pk_bf16_f32 v134, v41, v49
v_cvt_pk_bf16_f32 v138, v42, v50
v_cvt_pk_bf16_f32 v142, v43, v51
s_waitcnt vmcnt(4)
s_add_u32 s24, s24, 131072
s_add_u32 s25, s25, 131072
v_add_u32 v6, 256, v6
s_add_u32 s29, s29, 1
s_cmp_lg_u32 s29, 15
s_cbranch_scc1 L_v_go1
L_v_rk1:
s_barrier
L_v_go1:
ds_read_b64 v[72:73], v6
ds_read_b64 v[74:75], v6 offset:128
ds_read_b64 v[76:77], v6 offset:4096
ds_read_b64 v[78:79], v6 offset:4224
buffer_load_dwordx4 v[8:11], v5, s[8:11], s24 offen offset:0 nt
v_fma_f32 v119, v119, s64, v122
v_exp_f32 v119, v119
v_cvt_f32_i32 v52, v52
v_cvt_f32_i32 v53, v53
v_cvt_f32_i32 v54, v54
v_cvt_f32_i32 v55, v55
v_add_f32 v121, v121, v119
v_mul_f32 v119, v119, v87
v_pk_add_f32 v[52:53], v[52:53], v[92:93] op_sel:[0,1] op_sel_hi:[1,1] neg_lo:[0,1] neg_hi:[0,1]
v_pk_add_f32 v[54:55], v[54:55], v[92:93] op_sel:[0,1] op_sel_hi:[1,1] neg_lo:[0,1] neg_hi:[0,1]
v_cvt_pk_bf16_f32 v146, v44, v52
v_cvt_pk_bf16_f32 v150, v45, v53
v_cvt_pk_bf16_f32 v154, v46, v54
v_cvt_pk_bf16_f32 v158, v47, v55
s_waitcnt vmcnt(4)
buffer_load_dwordx4 v[12:15], v5, s[8:11], s24 offen offset:256 nt
v_cvt_f32_i32 v56, v56
v_cvt_f32_i32 v57, v57
v_cvt_f32_i32 v58, v58
v_cvt_f32_i32 v59, v59
v_cvt_pk_bf16_f32 v100, v112, v113
v_cvt_pk_bf16_f32 v101, v114, v115
v_cvt_pk_bf16_f32 v102, v116, v117
v_cvt_pk_bf16_f32 v103, v118, v119
v_pk_add_f32 v[56:57], v[56:57], v[94:95] op_sel:[0,0] op_sel_hi:[1,0] neg_lo:[0,1] neg_hi:[0,1]
v_pk_add_f32 v[58:59], v[58:59], v[94:95] op_sel:[0,0] op_sel_hi:[1,0] neg_lo:[0,1] neg_hi:[0,1]
s_waitcnt vmcnt(4)
buffer_load_dwordx4 v[16:19], v5, s[8:11], s24 offen offset:512 nt
v_cvt_f32_i32 v60, v60
v_cvt_f32_i32 v61, v61
v_cvt_f32_i32 v62, v62
v_cvt_f32_i32 v63, v63
v_pk_add_f32 v[60:61], v[60:61], v[94:95] op_sel:[0,0] op_sel_hi:[1,0] neg_lo:[0,1] neg_hi:[0,1]
v_pk_add_f32 v[62:63], v[62:63], v[94:95] op_sel:[0,0] op_sel_hi:[1,0] neg_lo:[0,1] neg_hi:[0,1]
s_waitcnt vmcnt(4)
buffer_load_dwordx4 v[20:23], v5, s[8:11], s24 offen offset:768 nt
v_cvt_f32_i32 v64, v64
v_cvt_f32_i32 v65, v65
v_cvt_f32_i32 v66, v66
v_cvt_f32_i32 v67, v67
v_pk_add_f32 v[64:65], v[64:65], v[94:95] op_sel:[0,1] op_sel_hi:[1,1] neg_lo:[0,1] neg_hi:[0,1]
v_pk_add_f32 v[66:67], v[66:67], v[94:95] op_sel:[0,1] op_sel_hi:[1,1] neg_lo:[0,1] neg_hi:[0,1]
v_cvt_pk_bf16_f32 v131, v56, v64
v_cvt_pk_bf16_f32 v135, v57, v65
v_cvt_pk_bf16_f32 v139, v58, v66
v_cvt_pk_bf16_f32 v143, v59, v67
s_nop 1
v_mfma_f32_16x16x32_bf16 v[160:163], v[100:103], v[128:131], v[160:163]
v_mfma_f32_16x16x32_bf16 v[164:167], v[100:103], v[132:135], v[164:167]
v_mfma_f32_16x16x32_bf16 v[168:171], v[100:103], v[136:139], v[168:171]
v_mfma_f32_16x16x32_bf16 v[172:175], v[100:103], v[140:143], v[172:175]
s_waitcnt vmcnt(4)
buffer_load_dwordx4 v[24:27], v5, s[8:11], s24 offen offset:1024 nt
v_cvt_f32_i32 v68, v68
v_cvt_f32_i32 v69, v69
v_cvt_f32_i32 v70, v70
v_cvt_f32_i32 v71, v71
v_pk_add_f32 v[68:69], v[68:69], v[94:95] op_sel:[0,1] op_sel_hi:[1,1] neg_lo:[0,1] neg_hi:[0,1]
v_pk_add_f32 v[70:71], v[70:71], v[94:95] op_sel:[0,1] op_sel_hi:[1,1] neg_lo:[0,1] neg_hi:[0,1]
v_cvt_pk_bf16_f32 v147, v60, v68
v_cvt_pk_bf16_f32 v151, v61, v69
v_cvt_pk_bf16_f32 v155, v62, v70
v_cvt_pk_bf16_f32 v159, v63, v71
s_nop 1
v_mfma_f32_16x16x32_bf16 v[176:179], v[100:103], v[144:147], v[176:179]
v_mfma_f32_16x16x32_bf16 v[180:183], v[100:103], v[148:151], v[180:183]
v_mfma_f32_16x16x32_bf16 v[184:187], v[100:103], v[152:155], v[184:187]
v_mfma_f32_16x16x32_bf16 v[188:191], v[100:103], v[156:159], v[188:191]
s_cmp_lt_u32 s29, s31
s_cbranch_scc1 L_v
buffer_load_dwordx4 v[28:31], v5, s[8:11], s24 offen offset:1280 nt
s_cmp_ge_u32 s29, 15
s_cbranch_scc1 L_vlast
L_vb:
ds_read_b128 v[112:115], v0
ds_read_b128 v[116:119], v0 offset:16
v_add_u32 v0, 512, v0
s_waitcnt vmcnt(5)
buffer_load_dwordx4 v[32:35], v5, s[8:11], s24 offen offset:1536 nt
s_waitcnt lgkmcnt(2)
v_lshlrev_b32 v80, 16, v72
v_and_b32 v81, 0xffff0000, v72
v_lshlrev_b32 v88, 16, v76
v_and_b32 v89, 0xffff0000, v76
v_cvt_f32_i32 v8, v8
v_cvt_f32_i32 v9, v9
v_cvt_f32_i32 v10, v10
v_cvt_f32_i32 v11, v11
v_pk_add_f32 v[8:9], v[8:9], v[88:89] op_sel:[0,0] op_sel_hi:[1,0] neg_lo:[0,1] neg_hi:[0,1]
v_pk_add_f32 v[10:11], v[10:11], v[88:89] op_sel:[0,0] op_sel_hi:[1,0] neg_lo:[0,1] neg_hi:[0,1]
s_waitcnt vmcnt(5)
buffer_load_dwordx4 v[36:39], v5, s[8:11], s24 offen offset:1792 nt
v_lshlrev_b32 v82, 16, v73
v_and_b32 v83, 0xffff0000, v73
v_lshlrev_b32 v90, 16, v77
v_and_b32 v91, 0xffff0000, v77
v_cvt_f32_i32 v12, v12
v_cvt_f32_i32 v13, v13
v_cvt_f32_i32 v14, v14
v_cvt_f32_i32 v15, v15
v_pk_add_f32 v[12:13], v[12:13], v[88:89] op_sel:[0,0] op_sel_hi:[1,0] neg_lo:[0,1] neg_hi:[0,1]
v_pk_add_f32 v[14:15], v[14:15], v[88:89] op_sel:[0,0] op_sel_hi:[1,0] neg_lo:[0,1] neg_hi:[0,1]
s_waitcnt vmcnt(5)
buffer_load_dwordx4 v[40:43], v5, s[8:11], s25 offen offset:0 nt
v_lshlrev_b32 v84, 16, v74
v_and_b32 v85, 0xffff0000, v74
v_lshlrev_b32 v92, 16, v78
v_and_b32 v93, 0xffff0000, v78
v_cvt_f32_i32 v16, v16
v_cvt_f32_i32 v17, v17
v_cvt_f32_i32 v18, v18
v_cvt_f32_i32 v19, v19
v_pk_add_f32 v[16:17], v[16:17], v[88:89] op_sel:[0,1] op_sel_hi:[1,1] neg_lo:[0,1] neg_hi:[0,1]
v_pk_add_f32 v[18:19], v[18:19], v[88:89] op_sel:[0,1] op_sel_hi:[1,1] neg_lo:[0,1] neg_hi:[0,1]
v_cvt_pk_bf16_f32 v128, v8, v16
v_cvt_pk_bf16_f32 v132, v9, v17
v_cvt_pk_bf16_f32 v136, v10, v18
v_cvt_pk_bf16_f32 v140, v11, v19
s_waitcnt vmcnt(5)
buffer_load_dwordx4 v[44:47], v5, s[8:11], s25 offen offset:256 nt
v_lshlrev_b32 v86, 16, v75
v_and_b32 v87, 0xffff0000, v75
v_lshlrev_b32 v94, 16, v79
v_and_b32 v95, 0xffff0000, v79
v_cvt_f32_i32 v20, v20
v_cvt_f32_i32 v21, v21
v_cvt_f32_i32 v22, v22
v_cvt_f32_i32 v23, v23
v_pk_add_f32 v[20:21], v[20:21], v[88:89] op_sel:[0,1] op_sel_hi:[1,1] neg_lo:[0,1] neg_hi:[0,1]
v_pk_add_f32 v[22:23], v[22:23], v[88:89] op_sel:[0,1] op_sel_hi:[1,1] neg_lo:[0,1] neg_hi:[0,1]
v_cvt_pk_bf16_f32 v144, v12, v20
v_cvt_pk_bf16_f32 v148, v13, v21
v_cvt_pk_bf16_f32 v152, v14, v22
v_cvt_pk_bf16_f32 v156, v15, v23
s_waitcnt vmcnt(5)
buffer_load_dwordx4 v[48:51], v5, s[8:11], s25 offen offset:512 nt
s_waitcnt lgkmcnt(0)
v_fma_f32 v112, v112, s64, v122
v_exp_f32 v112, v112
v_cvt_f32_i32 v24, v24
v_cvt_f32_i32 v25, v25
v_cvt_f32_i32 v26, v26
v_cvt_f32_i32 v27, v27
v_add_f32 v121, v121, v112
v_mul_f32 v112, v112, v80
v_pk_add_f32 v[24:25], v[24:25], v[90:91] op_sel:[0,0] op_sel_hi:[1,0] neg_lo:[0,1] neg_hi:[0,1]
v_pk_add_f32 v[26:27], v[26:27], v[90:91] op_sel:[0,0] op_sel_hi:[1,0] neg_lo:[0,1] neg_hi:[0,1]
s_waitcnt vmcnt(5)
buffer_load_dwordx4 v[52:55], v5, s[8:11], s25 offen offset:768 nt
v_fma_f32 v113, v113, s64, v122
v_exp_f32 v113, v113
v_cvt_f32_i32 v28, v28
v_cvt_f32_i32 v29, v29
v_cvt_f32_i32 v30, v30
v_cvt_f32_i32 v31, v31
v_add_f32 v121, v121, v113
v_mul_f32 v113, v113, v81
v_pk_add_f32 v[28:29], v[28:29], v[90:91] op_sel:[0,0] op_sel_hi:[1,0] neg_lo:[0,1] neg_hi:[0,1]
v_pk_add_f32 v[30:31], v[30:31], v[90:91] op_sel:[0,0] op_sel_hi:[1,0] neg_lo:[0,1] neg_hi:[0,1]
s_waitcnt vmcnt(5)
buffer_load_dwordx4 v[56:59], v5, s[8:11], s25 offen offset:1024 nt
v_fma_f32 v114, v114, s64, v122
v_exp_f32 v114, v114
v_cvt_f32_i32 v32, v32
v_cvt_f32_i32 v33, v33
v_cvt_f32_i32 v34, v34
v_cvt_f32_i32 v35, v35
v_add_f32 v121, v121, v114
v_mul_f32 v114, v114, v82
v_pk_add_f32 v[32:33], v[32:33], v[90:91] op_sel:[0,1] op_sel_hi:[1,1] neg_lo:[0,1] neg_hi:[0,1]
v_pk_add_f32 v[34:35], v[34:35], v[90:91] op_sel:[0,1] op_sel_hi:[1,1] neg_lo:[0,1] neg_hi:[0,1]
v_cvt_pk_bf16_f32 v129, v24, v32
v_cvt_pk_bf16_f32 v133, v25, v33
v_cvt_pk_bf16_f32 v137, v26, v34
v_cvt_pk_bf16_f32 v141, v27, v35
s_waitcnt vmcnt(5)
buffer_load_dwordx4 v[60:63], v5, s[8:11], s25 offen offset:1280 nt
v_fma_f32 v115, v115, s64, v122
v_exp_f32 v115, v115
v_cvt_f32_i32 v36, v36
v_cvt_f32_i32 v37, v37
v_cvt_f32_i32 v38, v38
v_cvt_f32_i32 v39, v39
v_add_f32 v121, v121, v115
v_mul_f32 v115, v115, v83
v_pk_add_f32 v[36:37], v[36:37], v[90:91] op_sel:[0,1] op_sel_hi:[1,1] neg_lo:[0,1] neg_hi:[0,1]
v_pk_add_f32 v[38:39], v[38:39], v[90:91] op_sel:[0,1] op_sel_hi:[1,1] neg_lo:[0,1] neg_hi:[0,1]
v_cvt_pk_bf16_f32 v145, v28, v36
v_cvt_pk_bf16_f32 v149, v29, v37
v_cvt_pk_bf16_f32 v153, v30, v38
v_cvt_pk_bf16_f32 v157, v31, v39
s_waitcnt vmcnt(5)
buffer_load_dwordx4 v[64:67], v5, s[8:11], s25 offen offset:1536 nt
v_fma_f32 v116, v116, s64, v122
v_exp_f32 v116, v116
v_cvt_f32_i32 v40, v40
v_cvt_f32_i32 v41, v41
v_cvt_f32_i32 v42, v42
v_cvt_f32_i32 v43, v43
v_add_f32 v121, v121, v116
v_mul_f32 v116, v116, v84
v_pk_add_f32 v[40:41], v[40:41], v[92:93] op_sel:[0,0] op_sel_hi:[1,0] neg_lo:[0,1] neg_hi:[0,1]
v_pk_add_f32 v[42:43], v[42:43], v[92:93] op_sel:[0,0] op_sel_hi:[1,0] neg_lo:[0,1] neg_hi:[0,1]
s_waitcnt vmcnt(5)
buffer_load_dwordx4 v[68:71], v5, s[8:11], s25 offen offset:1792 nt
v_fma_f32 v117, v117, s64, v122
v_exp_f32 v117, v117
v_cvt_f32_i32 v44, v44
v_cvt_f32_i32 v45, v45
v_cvt_f32_i32 v46, v46
v_cvt_f32_i32 v47, v47
v_add_f32 v121, v121, v117
v_mul_f32 v117, v117, v85
v_pk_add_f32 v[44:45], v[44:45], v[92:93] op_sel:[0,0] op_sel_hi:[1,0] neg_lo:[0,1] neg_hi:[0,1]
v_pk_add_f32 v[46:47], v[46:47], v[92:93] op_sel:[0,0] op_sel_hi:[1,0] neg_lo:[0,1] neg_hi:[0,1]
s_waitcnt vmcnt(5)
s_add_u32 s24, s24, 131072
s_add_u32 s25, s25, 131072
v_add_u32 v6, 256, v6
s_add_u32 s29, s29, 1
s_cmp_lg_u32 s29, 15
s_cbranch_scc1 L_v_go2
L_v_rk2:
s_barrier
L_v_go2:
ds_read_b64 v[72:73], v6
ds_read_b64 v[74:75], v6 offset:128
ds_read_b64 v[76:77], v6 offset:4096
ds_read_b64 v[78:79], v6 offset:4224
buffer_load_dwordx4 v[8:11], v5, s[8:11], s24 offen offset:0 nt
v_fma_f32 v118, v118, s64, v122
v_exp_f32 v118, v118
v_cvt_f32_i32 v48, v48
v_cvt_f32_i32 v49, v49
v_cvt_f32_i32 v50, v50
v_cvt_f32_i32 v51, v51
v_add_f32 v121, v121, v118
v_mul_f32 v118, v118, v86
v_pk_add_f32 v[48:49], v[48:49], v[92:93] op_sel:[0,1] op_sel_hi:[1,1] neg_lo:[0,1] neg_hi:[0,1]
v_pk_add_f32 v[50:51], v[50:51], v[92:93] op_sel:[0,1] op_sel_hi:[1,1] neg_lo:[0,1] neg_hi:[0,1]
v_cvt_pk_bf16_f32 v130, v40, v48
v_cvt_pk_bf16_f32 v134, v41, v49
v_cvt_pk_bf16_f32 v138, v42, v50
v_cvt_pk_bf16_f32 v142, v43, v51
s_waitcnt vmcnt(5)
buffer_load_dwordx4 v[12:15], v5, s[8:11], s24 offen offset:256 nt
v_fma_f32 v119, v119, s64, v122
v_exp_f32 v119, v119
v_cvt_f32_i32 v52, v52
v_cvt_f32_i32 v53, v53
v_cvt_f32_i32 v54, v54
v_cvt_f32_i32 v55, v55
v_add_f32 v121, v121, v119
v_mul_f32 v119, v119, v87
v_pk_add_f32 v[52:53], v[52:53], v[92:93] op_sel:[0,1] op_sel_hi:[1,1] neg_lo:[0,1] neg_hi:[0,1]
v_pk_add_f32 v[54:55], v[54:55], v[92:93] op_sel:[0,1] op_sel_hi:[1,1] neg_lo:[0,1] neg_hi:[0,1]
v_cvt_pk_bf16_f32 v146, v44, v52
v_cvt_pk_bf16_f32 v150, v45, v53
v_cvt_pk_bf16_f32 v154, v46, v54
v_cvt_pk_bf16_f32 v158, v47, v55
s_waitcnt vmcnt(5)
buffer_load_dwordx4 v[16:19], v5, s[8:11], s24 offen offset:512 nt
v_cvt_f32_i32 v56, v56
v_cvt_f32_i32 v57, v57
v_cvt_f32_i32 v58, v58
v_cvt_f32_i32 v59, v59
v_cvt_pk_bf16_f32 v100, v112, v113
v_cvt_pk_bf16_f32 v101, v114, v115
v_cvt_pk_bf16_f32 v102, v116, v117
v_cvt_pk_bf16_f32 v103, v118, v119
v_pk_add_f32 v[56:57], v[56:57], v[94:95] op_sel:[0,0] op_sel_hi:[1,0] neg_lo:[0,1] neg_hi:[0,1]
v_pk_add_f32 v[58:59], v[58:59], v[94:95] op_sel:[0,0] op_sel_hi:[1,0] neg_lo:[0,1] neg_hi:[0,1]
s_waitcnt vmcnt(5)
buffer_load_dwordx4 v[20:23], v5, s[8:11], s24 offen offset:768 nt
v_cvt_f32_i32 v60, v60
v_cvt_f32_i32 v61, v61
v_cvt_f32_i32 v62, v62
v_cvt_f32_i32 v63, v63
v_pk_add_f32 v[60:61], v[60:61], v[94:95] op_sel:[0,0] op_sel_hi:[1,0] neg_lo:[0,1] neg_hi:[0,1]
v_pk_add_f32 v[62:63], v[62:63], v[94:95] op_sel:[0,0] op_sel_hi:[1,0] neg_lo:[0,1] neg_hi:[0,1]
s_waitcnt vmcnt(5)
buffer_load_dwordx4 v[24:27], v5, s[8:11], s24 offen offset:1024 nt
v_cvt_f32_i32 v64, v64
v_cvt_f32_i32 v65, v65
v_cvt_f32_i32 v66, v66
v_cvt_f32_i32 v67, v67
v_pk_add_f32 v[64:65], v[64:65], v[94:95] op_sel:[0,1] op_sel_hi:[1,1] neg_lo:[0,1] neg_hi:[0,1]
v_pk_add_f32 v[66:67], v[66:67], v[94:95] op_sel:[0,1] op_sel_hi:[1,1] neg_lo:[0,1] neg_hi:[0,1]
v_cvt_pk_bf16_f32 v131, v56, v64
v_cvt_pk_bf16_f32 v135, v57, v65
v_cvt_pk_bf16_f32 v139, v58, v66
v_cvt_pk_bf16_f32 v143, v59, v67
s_nop 1
v_mfma_f32_16x16x32_bf16 v[160:163], v[100:103], v[128:131], v[160:163]
v_mfma_f32_16x16x32_bf16 v[164:167], v[100:103], v[132:135], v[164:167]
v_mfma_f32_16x16x32_bf16 v[168:171], v[100:103], v[136:139], v[168:171]
v_mfma_f32_16x16x32_bf16 v[172:175], v[100:103], v[140:143], v[172:175]
s_waitcnt vmcnt(5)
buffer_load_dwordx4 v[28:31], v5, s[8:11], s24 offen offset:1280 nt
v_cvt_f32_i32 v68, v68
v_cvt_f32_i32 v69, v69
v_cvt_f32_i32 v70, v70
v_cvt_f32_i32 v71, v71
v_pk_add_f32 v[68:69], v[68:69], v[94:95] op_sel:[0,1] op_sel_hi:[1,1] neg_lo:[0,1] neg_hi:[0,1]
v_pk_add_f32 v[70:71], v[70:71], v[94:95] op_sel:[0,1] op_sel_hi:[1,1] neg_lo:[0,1] neg_hi:[0,1]
v_cvt_pk_bf16_f32 v147, v60, v68
v_cvt_pk_bf16_f32 v151, v61, v69
v_cvt_pk_bf16_f32 v155, v62, v70
v_cvt_pk_bf16_f32 v159, v63, v71
s_nop 1
v_mfma_f32_16x16x32_bf16 v[176:179], v[100:103], v[144:147], v[176:179]
v_mfma_f32_16x16x32_bf16 v[180:183], v[100:103], v[148:151], v[180:183]
v_mfma_f32_16x16x32_bf16 v[184:187], v[100:103], v[152:155], v[184:187]
v_mfma_f32_16x16x32_bf16 v[188:191], v[100:103], v[156:159], v[188:191]
s_cmp_lt_u32 s29, 15
s_cbranch_scc1 L_vb
L_vlast:
s_waitcnt vmcnt(6)
ds_read_b128 v[112:115], v0
ds_read_b128 v[116:119], v0 offset:16
v_add_u32 v0, 512, v0
s_waitcnt vmcnt(5)
buffer_load_dwordx4 v[32:35], v5, s[8:11], s24 offen offset:1536 nt
buffer_load_dwordx4 v[36:39], v5, s[8:11], s24 offen offset:1792 nt
buffer_load_dwordx4 v[40:43], v5, s[8:11], s25 offen offset:0 nt
s_waitcnt lgkmcnt(2)
v_lshlrev_b32 v80, 16, v72
v_and_b32 v81, 0xffff0000, v72
v_lshlrev_b32 v88, 16, v76
v_and_b32 v89, 0xffff0000, v76
v_cvt_f32_i32 v8, v8
v_cvt_f32_i32 v9, v9
v_cvt_f32_i32 v10, v10
v_cvt_f32_i32 v11, v11
v_pk_add_f32 v[8:9], v[8:9], v[88:89] op_sel:[0,0] op_sel_hi:[1,0] neg_lo:[0,1] neg_hi:[0,1]
v_pk_add_f32 v[10:11], v[10:11], v[88:89] op_sel:[0,0] op_sel_hi:[1,0] neg_lo:[0,1] neg_hi:[0,1]
s_waitcnt vmcnt(7)
buffer_load_dwordx4 v[44:47], v5, s[8:11], s25 offen offset:256 nt
v_lshlrev_b32 v82, 16, v73
v_and_b32 v83, 0xffff0000, v73
v_lshlrev_b32 v90, 16, v77
v_and_b32 v91, 0xffff0000, v77
v_cvt_f32_i32 v12, v12
v_cvt_f32_i32 v13, v13
v_cvt_f32_i32 v14, v14
v_cvt_f32_i32 v15, v15
v_pk_add_f32 v[12:13], v[12:13], v[88:89] op_sel:[0,0] op_sel_hi:[1,0] neg_lo:[0,1] neg_hi:[0,1]
v_pk_add_f32 v[14:15], v[14:15], v[88:89] op_sel:[0,0] op_sel_hi:[1,0] neg_lo:[0,1] neg_hi:[0,1]
s_waitcnt vmcnt(7)
buffer_load_dwordx4 v[48:51], v5, s[8:11], s25 offen offset:512 nt
v_lshlrev_b32 v84, 16, v74
v_and_b32 v85, 0xffff0000, v74
v_lshlrev_b32 v92, 16, v78
v_and_b32 v93, 0xffff0000, v78
v_cvt_f32_i32 v16, v16
v_cvt_f32_i32 v17, v17
v_cvt_f32_i32 v18, v18
v_cvt_f32_i32 v19, v19
v_pk_add_f32 v[16:17], v[16:17], v[88:89] op_sel:[0,1] op_sel_hi:[1,1] neg_lo:[0,1] neg_hi:[0,1]
v_pk_add_f32 v[18:19], v[18:19], v[88:89] op_sel:[0,1] op_sel_hi:[1,1] neg_lo:[0,1] neg_hi:[0,1]
v_cvt_pk_bf16_f32 v128, v8, v16
v_cvt_pk_bf16_f32 v132, v9, v17
v_cvt_pk_bf16_f32 v136, v10, v18
v_cvt_pk_bf16_f32 v140, v11, v19
s_waitcnt vmcnt(7)
buffer_load_dwordx4 v[52:55], v5, s[8:11], s25 offen offset:768 nt
v_lshlrev_b32 v86, 16, v75
v_and_b32 v87, 0xffff0000, v75
v_lshlrev_b32 v94, 16, v79
v_and_b32 v95, 0xffff0000, v79
v_cvt_f32_i32 v20, v20
v_cvt_f32_i32 v21, v21
v_cvt_f32_i32 v22, v22
v_cvt_f32_i32 v23, v23
v_pk_add_f32 v[20:21], v[20:21], v[88:89] op_sel:[0,1] op_sel_hi:[1,1] neg_lo:[0,1] neg_hi:[0,1]
v_pk_add_f32 v[22:23], v[22:23], v[88:89] op_sel:[0,1] op_sel_hi:[1,1] neg_lo:[0,1] neg_hi:[0,1]
v_cvt_pk_bf16_f32 v144, v12, v20
v_cvt_pk_bf16_f32 v148, v13, v21
v_cvt_pk_bf16_f32 v152, v14, v22
v_cvt_pk_bf16_f32 v156, v15, v23
s_waitcnt vmcnt(7)
buffer_load_dwordx4 v[56:59], v5, s[8:11], s25 offen offset:1024 nt
s_waitcnt lgkmcnt(0)
v_fma_f32 v112, v112, s64, v122
v_exp_f32 v112, v112
v_cvt_f32_i32 v24, v24
v_cvt_f32_i32 v25, v25
v_cvt_f32_i32 v26, v26
v_cvt_f32_i32 v27, v27
v_add_f32 v121, v121, v112
v_mul_f32 v112, v112, v80
v_pk_add_f32 v[24:25], v[24:25], v[90:91] op_sel:[0,0] op_sel_hi:[1,0] neg_lo:[0,1] neg_hi:[0,1]
v_pk_add_f32 v[26:27], v[26:27], v[90:91] op_sel:[0,0] op_sel_hi:[1,0] neg_lo:[0,1] neg_hi:[0,1]
s_waitcnt vmcnt(7)
buffer_load_dwordx4 v[60:63], v5, s[8:11], s25 offen offset:1280 nt
v_fma_f32 v113, v113, s64, v122
v_exp_f32 v113, v113
v_cvt_f32_i32 v28, v28
v_cvt_f32_i32 v29, v29
v_cvt_f32_i32 v30, v30
v_cvt_f32_i32 v31, v31
v_add_f32 v121, v121, v113
v_mul_f32 v113, v113, v81
v_pk_add_f32 v[28:29], v[28:29], v[90:91] op_sel:[0,0] op_sel_hi:[1,0] neg_lo:[0,1] neg_hi:[0,1]
v_pk_add_f32 v[30:31], v[30:31], v[90:91] op_sel:[0,0] op_sel_hi:[1,0] neg_lo:[0,1] neg_hi:[0,1]
s_waitcnt vmcnt(7)
buffer_load_dwordx4 v[64:67], v5, s[8:11], s25 offen offset:1536 nt
v_fma_f32 v114, v114, s64, v122
v_exp_f32 v114, v114
v_cvt_f32_i32 v32, v32
v_cvt_f32_i32 v33, v33
v_cvt_f32_i32 v34, v34
v_cvt_f32_i32 v35, v35
v_add_f32 v121, v121, v114
v_mul_f32 v114, v114, v82
v_pk_add_f32 v[32:33], v[32:33], v[90:91] op_sel:[0,1] op_sel_hi:[1,1] neg_lo:[0,1] neg_hi:[0,1]
v_pk_add_f32 v[34:35], v[34:35], v[90:91] op_sel:[0,1] op_sel_hi:[1,1] neg_lo:[0,1] neg_hi:[0,1]
v_cvt_pk_bf16_f32 v129, v24, v32
v_cvt_pk_bf16_f32 v133, v25, v33
v_cvt_pk_bf16_f32 v137, v26, v34
v_cvt_pk_bf16_f32 v141, v27, v35
s_waitcnt vmcnt(7)
buffer_load_dwordx4 v[68:71], v5, s[8:11], s25 offen offset:1792 nt
v_fma_f32 v115, v115, s64, v122
v_exp_f32 v115, v115
v_cvt_f32_i32 v36, v36
v_cvt_f32_i32 v37, v37
v_cvt_f32_i32 v38, v38
v_cvt_f32_i32 v39, v39
v_add_f32 v121, v121, v115
v_mul_f32 v115, v115, v83
v_pk_add_f32 v[36:37], v[36:37], v[90:91] op_sel:[0,1] op_sel_hi:[1,1] neg_lo:[0,1] neg_hi:[0,1]
v_pk_add_f32 v[38:39], v[38:39], v[90:91] op_sel:[0,1] op_sel_hi:[1,1] neg_lo:[0,1] neg_hi:[0,1]
v_cvt_pk_bf16_f32 v145, v28, v36
v_cvt_pk_bf16_f32 v149, v29, v37
v_cvt_pk_bf16_f32 v153, v30, v38
v_cvt_pk_bf16_f32 v157, v31, v39
s_waitcnt vmcnt(7)
s_xor_b32 s26, s26, 4096
s_waitcnt lgkmcnt(0)
s_barrier
v_mov_b32 v125, 41088
ds_read_b32 v192, v125
s_lshl_b32 s56, s30, 4
s_add_u32 s56, s56, 40960
v_mov_b32 v194, s56
ds_read_b128 v[202:205], v194
v_fma_f32 v116, v116, s64, v122
v_exp_f32 v116, v116
v_cvt_f32_i32 v40, v40
v_cvt_f32_i32 v41, v41
v_cvt_f32_i32 v42, v42
v_cvt_f32_i32 v43, v43
v_add_f32 v121, v121, v116
v_mul_f32 v116, v116, v84
v_pk_add_f32 v[40:41], v[40:41], v[92:93] op_sel:[0,0] op_sel_hi:[1,0] neg_lo:[0,1] neg_hi:[0,1]
v_pk_add_f32 v[42:43], v[42:43], v[92:93] op_sel:[0,0] op_sel_hi:[1,0] neg_lo:[0,1] neg_hi:[0,1]
s_waitcnt vmcnt(6)
v_lshrrev_b32 v206, 4, v193
v_and_b32 v124, 15, v193
v_lshlrev_b32 v206, 9, v206
v_lshl_add_u32 v206, v124, 4, v206
s_lshl_b32 s56, s30, 11
s_add_u32 s56, s56, 32768
v_add_u32 v206, s56, v206
s_lshl_b32 s56, s30, 9
s_add_u32 s56, s56, 32768
v_lshl_add_u32 v207, v193, 3, s56
s_mov_b32 s60, 2141562277
s_lshr_b32 s56, s2, 1
s_lshl_b32 s56, s56, 10
s_lshl_b32 s57, s30, 8
s_add_u32 s56, s56, s57
v_lshl_add_u32 v195, v193, 2, s56
v_fma_f32 v117, v117, s64, v122
v_exp_f32 v117, v117
v_cvt_f32_i32 v44, v44
v_cvt_f32_i32 v45, v45
v_cvt_f32_i32 v46, v46
v_cvt_f32_i32 v47, v47
v_add_f32 v121, v121, v117
v_mul_f32 v117, v117, v85
v_pk_add_f32 v[44:45], v[44:45], v[92:93] op_sel:[0,0] op_sel_hi:[1,0] neg_lo:[0,1] neg_hi:[0,1]
v_pk_add_f32 v[46:47], v[46:47], v[92:93] op_sel:[0,0] op_sel_hi:[1,0] neg_lo:[0,1] neg_hi:[0,1]
s_waitcnt vmcnt(5)
s_waitcnt lgkmcnt(0)
v_readfirstlane_b32 s85, v192
s_bfe_u32 s58, s2, 0x10001
s_lshr_b32 s85, s85, s58
s_and_b32 s85, s85, 1
v_fma_f32 v118, v118, s64, v122
v_exp_f32 v118, v118
v_cvt_f32_i32 v48, v48
v_cvt_f32_i32 v49, v49
v_cvt_f32_i32 v50, v50
v_cvt_f32_i32 v51, v51
v_add_f32 v121, v121, v118
v_mul_f32 v118, v118, v86
v_pk_add_f32 v[48:49], v[48:49], v[92:93] op_sel:[0,1] op_sel_hi:[1,1] neg_lo:[0,1] neg_hi:[0,1]
v_pk_add_f32 v[50:51], v[50:51], v[92:93] op_sel:[0,1] op_sel_hi:[1,1] neg_lo:[0,1] neg_hi:[0,1]
v_cvt_pk_bf16_f32 v130, v40, v48
v_cvt_pk_bf16_f32 v134, v41, v49
v_cvt_pk_bf16_f32 v138, v42, v50
v_cvt_pk_bf16_f32 v142, v43, v51
s_waitcnt vmcnt(4)
s_waitcnt lgkmcnt(0)
v_max3_f32 v201, v202, v203, v204
v_max_f32 v201, v201, v205
v_sub_f32 v202, v202, v201
v_sub_f32 v203, v203, v201
v_sub_f32 v204, v204, v201
v_sub_f32 v205, v205, v201
v_mul_f32 v202, s64, v202
v_mul_f32 v203, s64, v203
v_mul_f32 v204, s64, v204
v_mul_f32 v205, s64, v205
v_exp_f32 v202, v202
v_exp_f32 v203, v203
v_exp_f32 v204, v204
v_exp_f32 v205, v205
v_fma_f32 v119, v119, s64, v122
v_exp_f32 v119, v119
v_cvt_f32_i32 v52, v52
v_cvt_f32_i32 v53, v53
v_cvt_f32_i32 v54, v54
v_cvt_f32_i32 v55, v55
v_add_f32 v121, v121, v119
v_mul_f32 v119, v119, v87
v_pk_add_f32 v[52:53], v[52:53], v[92:93] op_sel:[0,1] op_sel_hi:[1,1] neg_lo:[0,1] neg_hi:[0,1]
v_pk_add_f32 v[54:55], v[54:55], v[92:93] op_sel:[0,1] op_sel_hi:[1,1] neg_lo:[0,1] neg_hi:[0,1]
v_cvt_pk_bf16_f32 v146, v44, v52
v_cvt_pk_bf16_f32 v150, v45, v53
v_cvt_pk_bf16_f32 v154, v46, v54
v_cvt_pk_bf16_f32 v158, v47, v55
s_waitcnt vmcnt(3)
buffer_load_dwordx4 v[196:199], v200, s[80:83], s26 offen sc1
v_cvt_f32_i32 v56, v56
v_cvt_f32_i32 v57, v57
v_cvt_f32_i32 v58, v58
v_cvt_f32_i32 v59, v59
v_cvt_pk_bf16_f32 v100, v112, v113
v_cvt_pk_bf16_f32 v101, v114, v115
v_cvt_pk_bf16_f32 v102, v116, v117
v_cvt_pk_bf16_f32 v103, v118, v119
v_pk_add_f32 v[56:57], v[56:57], v[94:95] op_sel:[0,0] op_sel_hi:[1,0] neg_lo:[0,1] neg_hi:[0,1]
v_pk_add_f32 v[58:59], v[58:59], v[94:95] op_sel:[0,0] op_sel_hi:[1,0] neg_lo:[0,1] neg_hi:[0,1]
s_waitcnt vmcnt(3)
v_mov_b32 v123, v121
s_nop 1
v_permlane32_swap_b32 v121, v123
v_add_f32 v121, v121, v123
v_mov_b32 v123, v121
s_nop 1
v_permlane16_swap_b32 v121, v123
v_add_f32 v121, v121, v123
s_lshl_b32 s56, s30, 2
s_add_u32 s56, s56, 40960
v_bfe_u32 v124, v193, 2, 2
v_lshl_add_u32 v124, v124, 4, s56
s_mov_b64 exec, 0x1111
ds_write_b32 v124, v121 offset:64
s_mov_b64 exec, -1
v_cvt_f32_i32 v60, v60
v_cvt_f32_i32 v61, v61
v_cvt_f32_i32 v62, v62
v_cvt_f32_i32 v63, v63
v_pk_add_f32 v[60:61], v[60:61], v[94:95] op_sel:[0,0] op_sel_hi:[1,0] neg_lo:[0,1] neg_hi:[0,1]
v_pk_add_f32 v[62:63], v[62:63], v[94:95] op_sel:[0,0] op_sel_hi:[1,0] neg_lo:[0,1] neg_hi:[0,1]
s_waitcnt vmcnt(2)
v_cvt_f32_i32 v64, v64
v_cvt_f32_i32 v65, v65
v_cvt_f32_i32 v66, v66
v_cvt_f32_i32 v67, v67
v_pk_add_f32 v[64:65], v[64:65], v[94:95] op_sel:[0,1] op_sel_hi:[1,1] neg_lo:[0,1] neg_hi:[0,1]
v_pk_add_f32 v[66:67], v[66:67], v[94:95] op_sel:[0,1] op_sel_hi:[1,1] neg_lo:[0,1] neg_hi:[0,1]
v_cvt_pk_bf16_f32 v131, v56, v64
v_cvt_pk_bf16_f32 v135, v57, v65
v_cvt_pk_bf16_f32 v139, v58, v66
v_cvt_pk_bf16_f32 v143, v59, v67
s_nop 1
v_mfma_f32_16x16x32_bf16 v[160:163], v[100:103], v[128:131], v[160:163]
v_mfma_f32_16x16x32_bf16 v[164:167], v[100:103], v[132:135], v[164:167]
v_mfma_f32_16x16x32_bf16 v[168:171], v[100:103], v[136:139], v[168:171]
v_mfma_f32_16x16x32_bf16 v[172:175], v[100:103], v[140:143], v[172:175]
s_waitcnt vmcnt(1)
v_cvt_f32_i32 v68, v68
v_cvt_f32_i32 v69, v69
v_cvt_f32_i32 v70, v70
v_cvt_f32_i32 v71, v71
v_pk_add_f32 v[68:69], v[68:69], v[94:95] op_sel:[0,1] op_sel_hi:[1,1] neg_lo:[0,1] neg_hi:[0,1]
v_pk_add_f32 v[70:71], v[70:71], v[94:95] op_sel:[0,1] op_sel_hi:[1,1] neg_lo:[0,1] neg_hi:[0,1]
v_cvt_pk_bf16_f32 v147, v60, v68
v_cvt_pk_bf16_f32 v151, v61, v69
v_cvt_pk_bf16_f32 v155, v62, v70
v_cvt_pk_bf16_f32 v159, v63, v71
s_nop 1
v_mfma_f32_16x16x32_bf16 v[176:179], v[100:103], v[144:147], v[176:179]
v_mfma_f32_16x16x32_bf16 v[180:183], v[100:103], v[148:151], v[180:183]
v_mfma_f32_16x16x32_bf16 v[184:187], v[100:103], v[152:155], v[184:187]
v_mfma_f32_16x16x32_bf16 v[188:191], v[100:103], v[156:159], v[188:191]
s_cmp_eq_u32 s85, 0
s_cbranch_scc1 L_noearly
buffer_load_dwordx4 v[8:11], v200, s[80:83], s26 offen sc1
L_noearly:
s_nop 0
v_mov_b32 v128, v160
v_mov_b32 v129, v164
v_mov_b32 v130, v168
v_mov_b32 v131, v172
v_mov_b32 v132, v176
v_mov_b32 v133, v180
v_mov_b32 v134, v184
v_mov_b32 v135, v188
ds_write_b128 v206, v[128:131]
ds_write_b128 v206, v[132:135] offset:256
s_waitcnt lgkmcnt(0)
s_barrier
ds_read_b64 v[136:137], v207 offset:0
ds_read_b64 v[138:139], v207 offset:2048
ds_read_b64 v[140:141], v207 offset:4096
ds_read_b64 v[142:143], v207 offset:6144
ds_read_b128 v[132:135], v194 offset:64
s_cmp_lg_u32 s85, 0
s_cbranch_scc1 L_comb
s_xor_b32 s26, s26, 4096
v_xor_b32 v145, s60, v201
s_waitcnt lgkmcnt(1)
v_mul_f32 v144, v202, v136
v_mul_f32 v146, v202, v137
v_fmac_f32 v144, v203, v138
v_fmac_f32 v146, v203, v139
v_fmac_f32 v144, v204, v140
v_fmac_f32 v146, v204, v141
v_fmac_f32 v144, v205, v142
v_fmac_f32 v146, v205, v143
s_waitcnt lgkmcnt(0)
v_mul_f32 v147, v202, v132
v_fmac_f32 v147, v203, v133
v_fmac_f32 v147, v204, v134
v_fmac_f32 v147, v205, v135
v_xor_b32 v147, s60, v147
buffer_store_dwordx4 v[144:147], v200, s[80:83], s26 offen sc1
s_branch L_done
L_comb:
s_waitcnt vmcnt(1)
v_min_u32 v123, v197, v199
v_cmp_eq_u32 vcc, 0, v123
s_nop 4
s_cbranch_vccz L_got
s_branch L_chk
L_poll:
buffer_load_dwordx4 v[8:11], v200, s[80:83], s26 offen sc1
L_chk:
s_waitcnt vmcnt(0)
v_min_u32 v123, v9, v11
v_cmp_eq_u32 vcc, 0, v123
s_nop 4
s_cbranch_vccnz L_poll
v_mov_b32 v196, v8
v_mov_b32 v197, v9
v_mov_b32 v198, v10
v_mov_b32 v199, v11
L_got:
v_xor_b32 v197, s60, v197
v_xor_b32 v199, s60, v199
v_max_f32 v150, v201, v197
v_sub_f32 v148, v201, v150
v_sub_f32 v149, v197, v150
v_mul_f32 v148, s64, v148
v_mul_f32 v149, s64, v149
v_exp_f32 v148, v148
v_exp_f32 v149, v149
s_nop 0
v_mul_f32 v196, v149, v196
v_mul_f32 v198, v149, v198
v_mul_f32 v199, v149, v199
s_waitcnt lgkmcnt(1)
v_mul_f32 v144, v202, v136
v_mul_f32 v146, v202, v137
v_fmac_f32 v144, v203, v138
v_fmac_f32 v146, v203, v139
v_fmac_f32 v144, v204, v140
v_fmac_f32 v146, v204, v141
v_fmac_f32 v144, v205, v142
v_fmac_f32 v146, v205, v143
s_waitcnt lgkmcnt(0)
v_mul_f32 v147, v202, v132
v_fmac_f32 v147, v203, v133
v_fmac_f32 v147, v204, v134
v_fmac_f32 v147, v205, v135
v_fmac_f32 v199, v148, v147
v_fmac_f32 v196, v148, v144
v_rcp_f32 v150, v199
v_fmac_f32 v198, v148, v146
v_fma_f32 v128, -v150, v199, 1.0
v_fmac_f32 v150, v128, v150
v_mul_f32 v196, v196, v150
v_mul_f32 v198, v198, v150
v_cvt_pk_bf16_f32 v150, v196, v198
global_store_dword v195, v150, s[50:51]
L_done:
L_end:
s_endpgm
L_help:
s_lshr_b32 s59, s2, 3
s_and_b32 s59, s59, 0
s_mul_i32 s60, s59, 128
s_add_u32 s60, s60, 0
v_mov_b32 v1, s60
v_mov_b32 v2, 0x100
s_and_b32 s57, s2, 0xfc
s_bfe_u32 s58, s2, 0x10001
s_lshl_b32 s58, 1, s58
v_mov_b32 v3, s57
v_mov_b32 v4, s58
v_mov_b32 v5, 41088
v_lshrrev_b32 v13, 4, v0
v_and_b32 v14, 15, v0
v_lshlrev_b32 v13, 9, v13
v_lshl_add_u32 v13, v14, 4, v13
v_lshlrev_b32 v14, 4, v0
v_mov_b32 v16, 0
v_mov_b32 v17, 0
v_mov_b32 v18, 0
v_mov_b32 v19, 0
s_lshr_b32 s27, s2, 1
s_lshl_b32 s27, s27, 5
s_and_b32 s28, s2, 1
s_or_b32 s27, s27, s28
s_lshl_b32 s33, s27, 8
s_lshl_b32 s26, s2, 12
s_mov_b32 s15, 0x20000
s_mov_b32 s19, 0x20000
s_mov_b32 s83, 0x20000
s_mov_b32 s14, 0x100000
s_mov_b32 s18, 0x100000
s_mov_b32 s82, 0x100000
s_waitcnt lgkmcnt(0)
s_mov_b32 s12, s46
s_mov_b32 s13, s47
s_mov_b32 s16, s48
s_mov_b32 s17, s49
s_mov_b32 s80, s54
s_mov_b32 s81, s55
buffer_store_dwordx4 v[16:19], v14, s[80:83], s26 offen offset:0 sc1
buffer_store_dwordx4 v[16:19], v14, s[80:83], s26 offen offset:1024 sc1
buffer_store_dwordx4 v[16:19], v14, s[80:83], s26 offen offset:2048 sc1
buffer_store_dwordx4 v[16:19], v14, s[80:83], s26 offen offset:3072 sc1
s_barrier
s_waitcnt vmcnt(0)
s_mov_b64 exec, 1
s_barrier
s_barrier
global_atomic_xor v6, v3, v4, s[52:53] sc0
s_waitcnt vmcnt(0)
ds_write_b32 v5, v6
s_waitcnt lgkmcnt(0)
s_barrier
s_endpgm
.section .rodata,"a"
.p2align 6
.amdhsa_kernel standalone__kv_cache_quant_int4_int2_kv_with_per_channel_or_per_token_scales__sampling_kernel
  .amdhsa_next_free_vgpr 208
  .amdhsa_next_free_sgpr 96
  .amdhsa_accum_offset 208
  .amdhsa_group_segment_fixed_size 0
  .amdhsa_kernarg_size 80
  .amdhsa_user_sgpr_count 2
  .amdhsa_user_sgpr_kernarg_segment_ptr 1
  .amdhsa_system_sgpr_workgroup_id_x 1
.end_amdhsa_kernel
```
